```python
import torch

def _softmax(x, axis=-1):
    return torch.softmax(x, dim=axis)
def _gelu(x):
    return torch.nn.functional.gelu(x, approximate="tanh")
def _silu(x):
    return torch.nn.functional.silu(x)
def _sigmoid(x):
    return torch.sigmoid(x)
def _layernorm(x, axis=-1, eps=1e-5):
    m = x.mean(dim=axis, keepdim=True)
    v = x.var(dim=axis, keepdim=True, unbiased=False)
    return (x - m) / torch.sqrt(v + eps)
def _scatter_add(tgt, idx, src, axis=0):
    return tgt.clone().index_add_(axis, idx, src)
def _segment_sum(src, seg, n):
    out = torch.zeros((n,) + src.shape[1:], dtype=src.dtype)
    return out.index_add_(0, seg, src)
def _pad(x, pw):
    flat = tuple(v for pair in reversed(pw) for v in pair)
    return torch.nn.functional.pad(x, flat)

kernel_name = 'concat_heads__sliding_local_dilated__ssm_conv_h3__prompt'

def setup_inputs():

    _w = (lambda a: (lambda t: t.to(torch.bfloat16) if t.is_floating_point() else t)(torch.as_tensor(a)))
    def _A_setup():
        B, S, D = 1, 2048, 576
        return {
            "x": _w((lambda *s: torch.randn(*s, dtype=torch.bfloat16) * 0.2)(B, S, D)),
            "wqkv": _w((lambda *s: torch.randn(*s, dtype=torch.bfloat16) * 0.2)(D, 3 * D)),
            "wo": _w((lambda *s: torch.randn(*s, dtype=torch.bfloat16) * 0.05)(D, D)),
        }
    _A_in = _A_setup()

    def _B_setup():
        B, S, D = 1, 2048, 576
        ks = 4
        return {
            "q": _w((lambda *s: torch.randn(*s, dtype=torch.bfloat16) * 0.05)(B, S, D)),
            "k": _w((lambda *s: torch.randn(*s, dtype=torch.bfloat16) * 0.8)(B, S, D)),
            "v": _w((lambda *s: torch.randn(*s, dtype=torch.bfloat16) * 0.8)(B, S, D)),
            "shift_k": _w((lambda *s: torch.randn(*s, dtype=torch.bfloat16) * 0.8)(D, ks) * 0.5),
            "ssm_k": _w((lambda *s: torch.randn(*s, dtype=torch.bfloat16) * 3.2)(D, S) * (1.0 / S ** 0.5)),
            "ssm_D": _w((lambda *s: torch.randn(*s, dtype=torch.bfloat16) * 0.8)(D)),
        }
    _B_in = _B_setup()

    return {
        "A_x": _A_in["x"],
        "A_wqkv": _A_in["wqkv"],
        "A_wo": _A_in["wo"],
        "B_q": _B_in["q"],
        "B_k": _B_in["k"],
        "B_v": _B_in["v"],
        "B_shift_k": _B_in["shift_k"],
        "B_ssm_k": _B_in["ssm_k"],
        "B_ssm_D": _B_in["ssm_D"],
    }

def reference(A_x, A_wqkv, A_wo, B_q, B_k, B_v, B_shift_k, B_ssm_k, B_ssm_D):
    def _A_ref(x, wqkv, wo):
        B, S, D = x.shape
        H = 32; Dh = D // H
        W, dil = 8, 2
        qkv = (lambda x, *d: x.permute(*d))((x @ wqkv).reshape(B, S, 3, H, Dh), 2, 0, 3, 1, 4)
        q, k, v = qkv[0], qkv[1], qkv[2]
        scale = Dh ** -0.5
        pos = torch.arange(S)
        off = torch.arange(W) * dil
        idx = pos[:, None] - off[None, :]
        mask = idx >= 0
        idx_c = torch.where(mask, idx, 0).reshape(-1)
        kg = k[:, :, idx_c, :].reshape(B, H, S, W, Dh)
        vg = v[:, :, idx_c, :].reshape(B, H, S, W, Dh)
        logits = torch.einsum("bhsd,bhswd->bhsw", q, kg) * scale
        logits = torch.where(mask[None, None, :, :], logits, -1e9)
        attn = _softmax(logits, axis=-1)
        o = torch.einsum("bhsw,bhswd->bhsd", attn, vg)
        return (lambda x, *d: x.permute(*d))(o, 0, 2, 1, 3).reshape(B, S, D) @ wo

    def _B_ref(q, k, v, shift_k, ssm_k, ssm_D):
        B, S, D = q.shape
        ks = shift_k.shape[-1]
        k_pad = _pad(k, ((0, 0), (ks - 1, 0), (0, 0)))
        k_shift = torch.zeros_like(k)
        for t in range(ks):
            k_shift = k_shift + k_pad[:, t:t + S, :] * shift_k[:, ks - 1 - t][None, None, :]
        kv = k_shift * v
        L = 2 * S
        kv_pad = _pad(kv, ((0, 0), (0, S), (0, 0)))
        kf_pad = _pad(ssm_k, ((0, 0), (0, S)))
        kv_f = (lambda x, axes=(-2,-1): torch.fft.rfft2(x.float(), dim=axes))(kv_pad[:, None, :, :], axes=(1, 2))
        kf_f = (lambda x, axes=(-2,-1): torch.fft.rfft2(x.float(), dim=axes))(kf_pad[:, None, :], axes=(1, 2))
        kf_f = (lambda x, *d: x.permute(*d))(kf_f, 1, 2, 0)
        y_f = kv_f * kf_f[None, :, :, :]
        y = (lambda x, s, axes=(-2,-1): torch.fft.irfft2(x, s=s, dim=axes).to(torch.bfloat16))(y_f, (1, L), axes=(1, 2))[:, 0, :S, :]
        y = y + kv * ssm_D[None, None, :]
        return q * y

    a = _A_ref(A_x, A_wqkv, A_wo)
    b = _B_ref(B_q, B_k, B_v, B_shift_k, B_ssm_k, B_ssm_D)
    return torch.concatenate([a, b], axis=-1)
```

```asm
; @launch grid=(256,1,1) block=(512,1,1) lds=141376
.amdgcn_target "amdgcn-amd-amdhsa--gfx950"
.text
.set CODE_LPW, 16
.globl concat_heads__sliding_local_dilated__ssm_conv_h3__prompt_kernel
.p2align 8
.type concat_heads__sliding_local_dilated__ssm_conv_h3__prompt_kernel,@function
concat_heads__sliding_local_dilated__ssm_conv_h3__prompt_kernel:
    s_cmp_ge_u32 s2, 256
    s_cbranch_scc1 L_end
    s_load_dwordx16 s[4:19], s[0:1], 0
    s_load_dwordx8 s[20:27], s[0:1], 64
    s_memrealtime s[30:31]
    s_getpc_b64 s[32:33]
L_pc:
    s_lshr_b32 s34, s2, 3
    s_mul_i32 s34, s34, CODE_LPW*128
    v_and_b32 v3, 63, v0
    v_lshlrev_b32 v3, 7, v3
    v_add_u32 v3, s34, v3
    v_cmp_gt_u32 vcc, (L_end-L_pc), v3
    v_cmp_gt_u32 s[36:37], CODE_LPW, v0
    s_nop 0
    s_and_b64 vcc, vcc, s[36:37]
    s_and_saveexec_b64 s[36:37], vcc
    s_cbranch_execz cpf_1
    global_load_dword v247, v3, s[32:33]
cpf_1:
    s_mov_b64 exec, s[36:37]
    v_lshrrev_b32 v2, 6, v0
    v_and_b32 v1, 63, v0
    v_readfirstlane_b32 s29, v2
    s_waitcnt lgkmcnt(0)
    s_or_b32 s28, s30, 1
    s_cmp_ge_u32 s2, 176
    s_cbranch_scc1 L_bset
    s_and_b32 s36, s2, 7
    s_lshr_b32 s37, s2, 3
    s_lshr_b32 s38, s36, 2
    s_and_b32 s39, s36, 3
    s_mul_i32 s32, s38, 11
    s_lshr_b32 s40, s37, 1
    s_add_u32 s32, s32, s40
    s_and_b32 s40, s37, 1
    s_lshl_b32 s33, s39, 1
    s_add_u32 s33, s33, s40
    s_mul_i32 s34, s32, 96
    s_mov_b32 s44, s4
    s_and_b32 s45, s5, 0xffff
    s_mov_b32 s46, 2359296
    s_mov_b32 s47, 0x00020000
    s_mov_b32 s48, s6
    s_and_b32 s49, s7, 0xffff
    s_mov_b32 s50, 1990656
    s_mov_b32 s51, 0x00020000
    s_cmp_ge_u32 s29, 4
    s_cbranch_scc1 a1_loader
    s_and_b32 s96, s2, 7
    s_lshr_b32 s98, s96, 2
    s_and_b32 s96, s96, 3
    s_mul_i32 s98, s98, 1056
    s_mul_i32 s99, s37, 49
    s_add_u32 s98, s98, s99
    s_sub_u32 s98, s98, 16
    v_mov_b32 v5, 0x7fff0000
    s_movk_i32 s99, 1152
    v_add_u32 v4, s98, v1
    v_mul_lo_u32 v230, v4, s99
    v_cmp_gt_i32 vcc, 0, v4
    s_nop 1
    v_cndmask_b32 v230, v230, v5, vcc
    v_cmp_le_u32 vcc, 49, v1
    s_nop 1
    v_cndmask_b32 v230, v230, v5, vcc
    s_mul_i32 s99, s37, 27
    v_add_u32 v4, s99, v1
    v_mul_u32_u24 v6, 7282, v4
    v_lshrrev_b32 v6, 16, v6
    v_mul_u32_u24 v7, 9, v6
    v_sub_u32 v7, v4, v7
    v_mul_u32_u24 v8, 21846, v7
    v_lshrrev_b32 v8, 16, v8
    v_mul_u32_u24 v231, 3456, v6
    v_mul_u32_u24 v6, 1152, v8
    v_add_u32 v231, v231, v6
    v_mul_u32_u24 v8, 3, v8
    v_sub_u32 v7, v7, v8
    v_lshl_add_u32 v231, v7, 7, v231
    s_lshl_b32 s96, s96, 8
    v_add_u32 v231, s96, v231
    v_cmp_le_u32 vcc, 27, v1
    s_nop 1
    v_cndmask_b32 v231, v231, v5, vcc
    v_cmp_le_u32 vcc, 576, v4
    s_nop 1
    v_cndmask_b32 v231, v231, v5, vcc
    s_cmp_lg_u32 s29, 0
    s_cbranch_scc1 nz_2
    s_mov_b32 s92, s24
    s_and_b32 s93, s25, 0xffff
    s_mov_b32 s94, 256
    s_mov_b32 s95, 0x00020000
    v_mov_b32 v252, s28
    v_mov_b32 v253, 0
    v_mov_b32 v251, 0
    s_mov_b64 exec, 1
    buffer_atomic_cmpswap v[252:253], v251, s[92:95], 0 offen sc0 sc1
    s_mov_b64 exec, -1
nz_2:
    v_and_b32 v2, 15, v1
    v_lshrrev_b32 v3, 4, v1
    s_and_b32 s56, s29, 3
    s_lshr_b32 s57, s29, 2
    s_mul_i32 s57, s57, 3
    v_lshlrev_b32 v4, 2, v3
    v_sub_u32 v4, v2, v4
    v_add_u32 v5, 16, v4
    v_and_b32 v5, 0xfffffff1, v5
    v_cmp_eq_u32 s[64:65], 0, v5
    v_add_u32 v5, 15, v4
    v_and_b32 v5, 0xfffffff1, v5
    v_cmp_eq_u32 s[66:67], 0, v5
    v_add_u32 v5, 14, v4
    v_and_b32 v5, 0xfffffff1, v5
    v_cmp_eq_u32 s[68:69], 0, v5
    v_add_u32 v5, 13, v4
    v_and_b32 v5, 0xfffffff1, v5
    v_cmp_eq_u32 s[70:71], 0, v5
    v_add_u32 v5, 0, v4
    v_and_b32 v5, 0xfffffff1, v5
    v_cmp_eq_u32 s[72:73], 0, v5
    v_subrev_u32 v5, 1, v4
    v_and_b32 v5, 0xfffffff1, v5
    v_cmp_eq_u32 s[74:75], 0, v5
    v_subrev_u32 v5, 2, v4
    v_and_b32 v5, 0xfffffff1, v5
    v_cmp_eq_u32 s[76:77], 0, v5
    v_subrev_u32 v5, 3, v4
    v_and_b32 v5, 0xfffffff1, v5
    v_cmp_eq_u32 s[78:79], 0, v5
    v_cmp_gt_u32 s[80:81], 2, v3
    v_cmp_gt_u32 s[82:83], 3, v3
    s_or_b32 s58, s32, s57
    s_cmp_eq_u32 s58, 0
    s_cselect_b64 s[84:85], 0, s[64:65]
    s_cmp_eq_u32 s58, 0
    s_cselect_b64 s[86:87], 0, s[66:67]
    s_cmp_eq_u32 s58, 0
    s_cselect_b64 s[88:89], 0, s[68:69]
    s_cmp_eq_u32 s58, 0
    s_cselect_b64 s[90:91], 0, s[70:71]
    v_min_u32 v5, 2, v3
    v_mul_u32_u24 v6, 48, v2
    v_lshl_add_u32 v6, v5, 4, v6
    s_mul_i32 s58, s56, 5376
    s_mul_i32 s59, s57, 768
    s_add_u32 s58, s58, s59
    v_add_u32 v220, s58, v6
    v_lshrrev_b32 v5, 2, v2
    v_lshl_add_u32 v5, v3, 2, v5
    v_mul_u32_u24 v5, 48, v5
    v_and_b32 v6, 3, v2
    v_lshl_add_u32 v5, v6, 3, v5
    v_add_u32 v221, s58, v5
    v_mul_u32_u24 v5, 144, v2
    v_lshl_add_u32 v5, v3, 3, v5
    s_mul_i32 s58, s56, 36
    s_mul_i32 s59, s57, 2304
    s_add_u32 s58, s58, s59
    s_add_u32 s58, s58, 69888
    v_add_u32 v222, s58, v5
    v_add_u32 v223, 2304, v222
    v_add_u32 v224, 4608, v222
    v_mov_b32 v225, 0xff800000
    s_mul_i32 s58, s32, 110592
    s_mul_i32 s59, s33, 2304
    s_add_u32 s58, s58, s59
    v_add_u32 v4, 0, v0
    v_and_b32 v5, 15, v4
    v_lshrrev_b32 v6, 4, v4
    v_mul_u32_u24 v7, 7282, v6
    v_lshrrev_b32 v7, 16, v7
    v_mul_u32_u24 v8, 9, v7
    v_sub_u32 v6, v6, v8
    v_lshl_add_u32 v8, v7, 4, v5
    v_mul_u32_u24 v8, 144, v8
    v_lshl_add_u32 v8, v6, 4, v8
    v_add_u32 v228, 69888, v8
    v_mul_u32_u24 v7, 18432, v7
    v_lshl_add_u32 v7, v6, 8, v7
    v_lshl_add_u32 v7, v5, 4, v7
    v_add_u32 v226, s58, v7
    v_add_u32 v4, 512, v0
    v_and_b32 v5, 15, v4
    v_lshrrev_b32 v6, 4, v4
    v_mul_u32_u24 v7, 7282, v6
    v_lshrrev_b32 v7, 16, v7
    v_mul_u32_u24 v8, 9, v7
    v_sub_u32 v6, v6, v8
    v_lshl_add_u32 v8, v7, 4, v5
    v_mul_u32_u24 v8, 144, v8
    v_lshl_add_u32 v8, v6, 4, v8
    v_add_u32 v229, 69888, v8
    v_mul_u32_u24 v7, 18432, v7
    v_lshl_add_u32 v7, v6, 8, v7
    v_lshl_add_u32 v7, v5, 4, v7
    v_add_u32 v227, s58, v7
    v_mov_b32 v5, 0x7fff0000
    v_cmp_gt_u32 vcc, 864, v4
    s_nop 1
    v_cndmask_b32 v227, v5, v227, vcc
    v_lshrrev_b32 v6, 2, v2
    v_lshl_add_u32 v7, v3, 3, v6
    v_mul_u32_u24 v7, 448, v7
    v_and_b32 v8, 3, v2
    v_lshl_add_u32 v7, v8, 3, v7
    v_add_u32 v7, 14336, v7
    v_and_b32 v8, 1, v3
    v_lshlrev_b32 v8, 5, v8
    v_lshrrev_b32 v9, 1, v2
    v_xor_b32 v9, v9, v3
    v_lshlrev_b32 v9, 4, v9
    v_lshl_add_u32 v14, v2, 7, v9
    v_xor_b32 v15, 64, v14
    s_cmp_eq_u32 s29, 0
    s_cbranch_scc1 a1_c0
    s_cmp_eq_u32 s29, 1
    s_cbranch_scc1 a1_c1
    s_cmp_eq_u32 s29, 2
    s_cbranch_scc1 a1_c2
a1_c3:
    v_add_u32 v10, v7, v8
    v_sub_u32 v11, v7, v8
    v_mov_b32 v12, v10
    v_mov_b32 v13, v10
    v_mul_u32_u24 v4, 48, v2
    v_lshlrev_b32 v5, 2, v3
    v_add_u32 v5, 144, v5
    v_mul_u32_u24 v6, 3641, v5
    v_lshrrev_b32 v6, 16, v6
    v_mul_u32_u24 v6, 5340, v6
    v_lshl_add_u32 v212, v5, 1, v6
    v_add_u32 v212, v212, v4
    v_lshlrev_b32 v5, 2, v3
    v_add_u32 v5, 146, v5
    v_mul_u32_u24 v6, 3641, v5
    v_lshrrev_b32 v6, 16, v6
    v_mul_u32_u24 v6, 5340, v6
    v_lshl_add_u32 v213, v5, 1, v6
    v_add_u32 v213, v213, v4
    v_lshlrev_b32 v5, 2, v3
    v_add_u32 v5, 160, v5
    v_mul_u32_u24 v6, 3641, v5
    v_lshrrev_b32 v6, 16, v6
    v_mul_u32_u24 v6, 5340, v6
    v_lshl_add_u32 v214, v5, 1, v6
    v_add_u32 v214, v214, v4
    v_lshlrev_b32 v5, 2, v3
    v_add_u32 v5, 162, v5
    v_mul_u32_u24 v6, 3641, v5
    v_lshrrev_b32 v6, 16, v6
    v_mul_u32_u24 v6, 5340, v6
    v_lshl_add_u32 v215, v5, 1, v6
    v_add_u32 v215, v215, v4
    v_lshlrev_b32 v5, 2, v3
    v_add_u32 v5, 176, v5
    v_mul_u32_u24 v6, 3641, v5
    v_lshrrev_b32 v6, 16, v6
    v_mul_u32_u24 v6, 5340, v6
    v_lshl_add_u32 v216, v5, 1, v6
    v_add_u32 v216, v216, v4
    v_lshlrev_b32 v5, 2, v3
    v_add_u32 v5, 178, v5
    v_mul_u32_u24 v6, 3641, v5
    v_lshrrev_b32 v6, 16, v6
    v_mul_u32_u24 v6, 5340, v6
    v_lshl_add_u32 v217, v5, 1, v6
    v_add_u32 v217, v217, v4
    v_lshlrev_b32 v5, 2, v3
    v_add_u32 v5, 192, v5
    v_mul_u32_u24 v6, 3641, v5
    v_lshrrev_b32 v6, 16, v6
    v_mul_u32_u24 v6, 5340, v6
    v_lshl_add_u32 v218, v5, 1, v6
    v_add_u32 v218, v218, v4
    v_lshlrev_b32 v5, 2, v3
    v_add_u32 v5, 194, v5
    v_mul_u32_u24 v6, 3641, v5
    v_lshrrev_b32 v6, 16, v6
    v_mul_u32_u24 v6, 5340, v6
    v_lshl_add_u32 v219, v5, 1, v6
    v_add_u32 v219, v219, v4
    v_mov_b64 v[28:29], 0
    v_mov_b64 v[30:31], 0
    v_mov_b64 v[32:33], 0
    v_mov_b64 v[34:35], 0
    v_mov_b64 v[36:37], 0
    v_mov_b64 v[38:39], 0
    v_mov_b64 v[40:41], 0
    v_mov_b64 v[42:43], 0
    v_mov_b64 v[44:45], 0
    v_mov_b64 v[46:47], 0
    v_mov_b64 v[48:49], 0
    v_mov_b64 v[50:51], 0
    v_mov_b64 v[52:53], 0
    v_mov_b64 v[54:55], 0
    v_mov_b64 v[56:57], 0
    v_mov_b64 v[58:59], 0
    v_mov_b64 v[60:61], 0
    v_mov_b64 v[62:63], 0
    v_mov_b64 v[64:65], 0
    v_mov_b64 v[66:67], 0
    v_mov_b64 v[68:69], 0
    v_mov_b64 v[70:71], 0
    v_mov_b64 v[72:73], 0
    v_mov_b64 v[74:75], 0
    v_mov_b64 v[76:77], 0
    v_mov_b64 v[78:79], 0
    v_mov_b64 v[80:81], 0
    v_mov_b64 v[82:83], 0
    v_mov_b64 v[84:85], 0
    v_mov_b64 v[86:87], 0
    v_mov_b64 v[88:89], 0
    v_mov_b64 v[90:91], 0
    v_mov_b64 v[92:93], 0
    v_mov_b64 v[94:95], 0
    v_mov_b64 v[96:97], 0
    v_mov_b64 v[98:99], 0
    v_mov_b64 v[100:101], 0
    v_mov_b64 v[102:103], 0
    v_mov_b64 v[104:105], 0
    v_mov_b64 v[106:107], 0
    v_mov_b64 v[108:109], 0
    v_mov_b64 v[110:111], 0
    v_mov_b64 v[112:113], 0
    v_mov_b64 v[114:115], 0
    v_mov_b64 v[116:117], 0
    v_mov_b64 v[118:119], 0
    v_mov_b64 v[120:121], 0
    v_mov_b64 v[122:123], 0
    s_mov_b32 s60, 0
    s_mov_b32 s61, 0
    s_mov_b32 s52, 43008
    s_mov_b32 s53, 4294881280
    s_barrier
    ds_read_b64_tr_b16 v[124:125], v11 offset:288
    ds_read_b64_tr_b16 v[126:127], v11 offset:2080
    ds_read_b64_tr_b16 v[128:129], v10 offset:320
    ds_read_b64_tr_b16 v[130:131], v10 offset:2112
    ds_read_b64_tr_b16 v[132:133], v11 offset:352
    ds_read_b64_tr_b16 v[134:135], v11 offset:2144
    ds_read_b64_tr_b16 v[136:137], v10 offset:384
    ds_read_b64_tr_b16 v[138:139], v10 offset:2176
    ds_read_b128 v[140:143], v14 offset:2048
    ds_read_b128 v[144:147], v14 offset:4096
    ds_read_b128 v[148:151], v14 offset:6144
    ds_read_b128 v[152:155], v14 offset:8192
    ds_read_b128 v[156:159], v14 offset:10240
    ds_read_b128 v[160:163], v14 offset:12288
    s_waitcnt lgkmcnt(0)
    s_branch a1_q3
a1_l3:
    s_barrier
    v_mfma_f32_16x16x32_bf16 v[28:31], v[168:171], v[184:187], v[28:31]
    ds_read_b64_tr_b16 v[124:125], v11 offset:288
    v_mfma_f32_16x16x32_bf16 v[32:35], v[168:171], v[188:191], v[32:35]
    ds_read_b64_tr_b16 v[126:127], v11 offset:2080
    v_mfma_f32_16x16x32_bf16 v[36:39], v[168:171], v[192:195], v[36:39]
    ds_read_b64_tr_b16 v[128:129], v10 offset:320
    v_mfma_f32_16x16x32_bf16 v[40:43], v[168:171], v[196:199], v[40:43]
    ds_read_b64_tr_b16 v[130:131], v10 offset:2112
    v_mfma_f32_16x16x32_bf16 v[44:47], v[168:171], v[200:203], v[44:47]
    ds_read_b64_tr_b16 v[132:133], v11 offset:352
    v_mfma_f32_16x16x32_bf16 v[48:51], v[168:171], v[204:207], v[48:51]
    ds_read_b64_tr_b16 v[134:135], v11 offset:2144
    v_mfma_f32_16x16x32_bf16 v[52:55], v[172:175], v[184:187], v[52:55]
    ds_read_b64_tr_b16 v[136:137], v10 offset:384
    v_mfma_f32_16x16x32_bf16 v[56:59], v[172:175], v[188:191], v[56:59]
    ds_read_b64_tr_b16 v[138:139], v10 offset:2176
    v_mfma_f32_16x16x32_bf16 v[60:63], v[172:175], v[192:195], v[60:63]
    ds_read_b128 v[140:143], v14 offset:2048
    v_mfma_f32_16x16x32_bf16 v[64:67], v[172:175], v[196:199], v[64:67]
    ds_read_b128 v[144:147], v14 offset:4096
    v_mfma_f32_16x16x32_bf16 v[68:71], v[172:175], v[200:203], v[68:71]
    ds_read_b128 v[148:151], v14 offset:6144
    v_mfma_f32_16x16x32_bf16 v[72:75], v[172:175], v[204:207], v[72:75]
    ds_read_b128 v[152:155], v14 offset:8192
    v_mfma_f32_16x16x32_bf16 v[76:79], v[176:179], v[184:187], v[76:79]
    ds_read_b128 v[156:159], v14 offset:10240
    v_mfma_f32_16x16x32_bf16 v[80:83], v[176:179], v[188:191], v[80:83]
    ds_read_b128 v[160:163], v14 offset:12288
    v_mfma_f32_16x16x32_bf16 v[84:87], v[176:179], v[192:195], v[84:87]
    v_mfma_f32_16x16x32_bf16 v[88:91], v[176:179], v[196:199], v[88:91]
    v_mfma_f32_16x16x32_bf16 v[92:95], v[176:179], v[200:203], v[92:95]
    v_mfma_f32_16x16x32_bf16 v[96:99], v[176:179], v[204:207], v[96:99]
    v_mfma_f32_16x16x32_bf16 v[100:103], v[180:183], v[184:187], v[100:103]
    v_mfma_f32_16x16x32_bf16 v[104:107], v[180:183], v[188:191], v[104:107]
    v_mfma_f32_16x16x32_bf16 v[108:111], v[180:183], v[192:195], v[108:111]
    v_mfma_f32_16x16x32_bf16 v[112:115], v[180:183], v[196:199], v[112:115]
    v_mfma_f32_16x16x32_bf16 v[116:119], v[180:183], v[200:203], v[116:119]
    v_mfma_f32_16x16x32_bf16 v[120:123], v[180:183], v[204:207], v[120:123]
    s_waitcnt lgkmcnt(0)
a1_q3:
    s_cmp_lg_u32 s60, 3
    s_cbranch_scc1 lpf_3
    s_add_u32 s63, s60, 9
    s_cmp_gt_u32 s63, 8
    s_cbranch_scc1 lpf_3
    s_lshl_b32 s96, s63, 7
    s_mul_i32 s97, s63, 221184
    buffer_load_dword v240, v231, s[48:51], s97 offen
    buffer_load_dword v241, v230, s[44:47], s96 offen
lpf_3:
    s_cmp_lg_u32 s60, 3
    s_cbranch_scc1 hpf_4
    s_cmp_ge_u32 s2, 64
    s_cbranch_scc1 hpf_4
    s_and_b32 s98, s2, 7
    s_lshr_b32 s97, s2, 3
    s_add_u32 s97, s97, 10
    s_lshl_b32 s96, s98, 4
    s_add_u32 s96, s96, s97
    s_lshl_b32 s99, s98, 1
    s_add_u32 s99, s99, s97
    s_add_u32 s99, s99, 112
    s_cmp_lt_u32 s97, 16
    s_cselect_b32 s96, s96, s99
    s_lshl_b32 s96, s96, 14
    s_add_u32 s92, s18, s96
    s_addc_u32 s93, s19, 0
    s_and_b32 s93, s93, 0xffff
    s_mov_b32 s94, 16384
    s_mov_b32 s95, 0x00020000
    v_lshlrev_b32 v232, 7, v1
    buffer_load_dword v242, v232, s[92:95], 0 offen
    v_add_u32 v232, 8192, v232
    buffer_load_dword v243, v232, s[92:95], 0 offen
hpf_4:
    s_add_u32 s61, s61, 1
    s_cmp_eq_u32 s61, 3
    s_cselect_b32 s62, s53, s52
    s_cselect_b32 s61, 0, s61
    v_mfma_f32_16x16x32_bf16 v[28:31], v[124:127], v[140:143], v[28:31]
    ds_read_b64_tr_b16 v[168:169], v11 offset:14624
    v_mfma_f32_16x16x32_bf16 v[32:35], v[124:127], v[144:147], v[32:35]
    ds_read_b64_tr_b16 v[170:171], v11 offset:16416
    v_mfma_f32_16x16x32_bf16 v[36:39], v[124:127], v[148:151], v[36:39]
    ds_read_b64_tr_b16 v[172:173], v10 offset:14656
    v_mfma_f32_16x16x32_bf16 v[40:43], v[124:127], v[152:155], v[40:43]
    ds_read_b64_tr_b16 v[174:175], v10 offset:16448
    v_mfma_f32_16x16x32_bf16 v[44:47], v[124:127], v[156:159], v[44:47]
    ds_read_b64_tr_b16 v[176:177], v11 offset:14688
    v_mfma_f32_16x16x32_bf16 v[48:51], v[124:127], v[160:163], v[48:51]
    ds_read_b64_tr_b16 v[178:179], v11 offset:16480
    v_mfma_f32_16x16x32_bf16 v[52:55], v[128:131], v[140:143], v[52:55]
    ds_read_b64_tr_b16 v[180:181], v10 offset:14720
    v_mfma_f32_16x16x32_bf16 v[56:59], v[128:131], v[144:147], v[56:59]
    ds_read_b64_tr_b16 v[182:183], v10 offset:16512
    v_mfma_f32_16x16x32_bf16 v[60:63], v[128:131], v[148:151], v[60:63]
    ds_read_b128 v[184:187], v15 offset:2048
    v_mfma_f32_16x16x32_bf16 v[64:67], v[128:131], v[152:155], v[64:67]
    ds_read_b128 v[188:191], v15 offset:4096
    v_mfma_f32_16x16x32_bf16 v[68:71], v[128:131], v[156:159], v[68:71]
    ds_read_b128 v[192:195], v15 offset:6144
    v_mfma_f32_16x16x32_bf16 v[72:75], v[128:131], v[160:163], v[72:75]
    ds_read_b128 v[196:199], v15 offset:8192
    v_mfma_f32_16x16x32_bf16 v[76:79], v[132:135], v[140:143], v[76:79]
    ds_read_b128 v[200:203], v15 offset:10240
    v_mfma_f32_16x16x32_bf16 v[80:83], v[132:135], v[144:147], v[80:83]
    ds_read_b128 v[204:207], v15 offset:12288
    v_mfma_f32_16x16x32_bf16 v[84:87], v[132:135], v[148:151], v[84:87]
    v_mfma_f32_16x16x32_bf16 v[88:91], v[132:135], v[152:155], v[88:91]
    v_mfma_f32_16x16x32_bf16 v[92:95], v[132:135], v[156:159], v[92:95]
    v_mfma_f32_16x16x32_bf16 v[96:99], v[132:135], v[160:163], v[96:99]
    v_mfma_f32_16x16x32_bf16 v[100:103], v[136:139], v[140:143], v[100:103]
    v_mfma_f32_16x16x32_bf16 v[104:107], v[136:139], v[144:147], v[104:107]
    v_mfma_f32_16x16x32_bf16 v[108:111], v[136:139], v[148:151], v[108:111]
    v_mfma_f32_16x16x32_bf16 v[112:115], v[136:139], v[152:155], v[112:115]
    v_mfma_f32_16x16x32_bf16 v[116:119], v[136:139], v[156:159], v[116:119]
    v_mfma_f32_16x16x32_bf16 v[120:123], v[136:139], v[160:163], v[120:123]
    v_add_u32 v10, s62, v10
    v_add_u32 v11, s62, v11
    v_add_u32 v12, s62, v12
    v_add_u32 v13, s62, v13
    v_add_u32 v14, s62, v14
    v_add_u32 v15, s62, v15
    s_add_u32 s60, s60, 1
    s_cmp_lt_u32 s60, 9
    s_waitcnt lgkmcnt(0)
    s_cbranch_scc1 a1_l3
    s_barrier
    v_mfma_f32_16x16x32_bf16 v[28:31], v[168:171], v[184:187], v[28:31]
    v_mfma_f32_16x16x32_bf16 v[32:35], v[168:171], v[188:191], v[32:35]
    v_mfma_f32_16x16x32_bf16 v[36:39], v[168:171], v[192:195], v[36:39]
    v_mfma_f32_16x16x32_bf16 v[40:43], v[168:171], v[196:199], v[40:43]
    s_nop 4
    v_cvt_pk_bf16_f32 v124, v28, v29
    v_cvt_pk_bf16_f32 v125, v30, v31
    ds_write_b32 v212, v124 offset:768
    ds_write_b32 v213, v125 offset:768
    v_mfma_f32_16x16x32_bf16 v[44:47], v[168:171], v[200:203], v[44:47]
    v_cvt_pk_bf16_f32 v126, v32, v33
    v_cvt_pk_bf16_f32 v127, v34, v35
    ds_write_b32 v212, v126 offset:1536
    ds_write_b32 v213, v127 offset:1536
    v_mfma_f32_16x16x32_bf16 v[48:51], v[168:171], v[204:207], v[48:51]
    v_cvt_pk_bf16_f32 v128, v36, v37
    v_cvt_pk_bf16_f32 v129, v38, v39
    ds_write_b32 v212, v128 offset:2304
    ds_write_b32 v213, v129 offset:2304
    v_mfma_f32_16x16x32_bf16 v[52:55], v[172:175], v[184:187], v[52:55]
    v_cvt_pk_bf16_f32 v130, v40, v41
    v_cvt_pk_bf16_f32 v131, v42, v43
    ds_write_b32 v212, v130 offset:3072
    ds_write_b32 v213, v131 offset:3072
    v_mfma_f32_16x16x32_bf16 v[56:59], v[172:175], v[188:191], v[56:59]
    v_cvt_pk_bf16_f32 v132, v44, v45
    v_cvt_pk_bf16_f32 v133, v46, v47
    ds_write_b32 v212, v132 offset:3840
    ds_write_b32 v213, v133 offset:3840
    v_mfma_f32_16x16x32_bf16 v[60:63], v[172:175], v[192:195], v[60:63]
    v_cvt_pk_bf16_f32 v134, v48, v49
    v_cvt_pk_bf16_f32 v135, v50, v51
    ds_write_b32 v212, v134 offset:4608
    ds_write_b32 v213, v135 offset:4608
    v_mfma_f32_16x16x32_bf16 v[64:67], v[172:175], v[196:199], v[64:67]
    v_cvt_pk_bf16_f32 v136, v52, v53
    v_cvt_pk_bf16_f32 v137, v54, v55
    ds_write_b32 v214, v136 offset:768
    ds_write_b32 v215, v137 offset:768
    v_mfma_f32_16x16x32_bf16 v[68:71], v[172:175], v[200:203], v[68:71]
    v_cvt_pk_bf16_f32 v138, v56, v57
    v_cvt_pk_bf16_f32 v139, v58, v59
    ds_write_b32 v214, v138 offset:1536
    ds_write_b32 v215, v139 offset:1536
    v_mfma_f32_16x16x32_bf16 v[72:75], v[172:175], v[204:207], v[72:75]
    v_cvt_pk_bf16_f32 v124, v60, v61
    v_cvt_pk_bf16_f32 v125, v62, v63
    ds_write_b32 v214, v124 offset:2304
    ds_write_b32 v215, v125 offset:2304
    v_mfma_f32_16x16x32_bf16 v[76:79], v[176:179], v[184:187], v[76:79]
    v_cvt_pk_bf16_f32 v126, v64, v65
    v_cvt_pk_bf16_f32 v127, v66, v67
    ds_write_b32 v214, v126 offset:3072
    ds_write_b32 v215, v127 offset:3072
    v_mfma_f32_16x16x32_bf16 v[80:83], v[176:179], v[188:191], v[80:83]
    v_cvt_pk_bf16_f32 v128, v68, v69
    v_cvt_pk_bf16_f32 v129, v70, v71
    ds_write_b32 v214, v128 offset:3840
    ds_write_b32 v215, v129 offset:3840
    v_mfma_f32_16x16x32_bf16 v[84:87], v[176:179], v[192:195], v[84:87]
    v_cvt_pk_bf16_f32 v130, v72, v73
    v_cvt_pk_bf16_f32 v131, v74, v75
    ds_write_b32 v214, v130 offset:4608
    ds_write_b32 v215, v131 offset:4608
    v_mfma_f32_16x16x32_bf16 v[88:91], v[176:179], v[196:199], v[88:91]
    v_cvt_pk_bf16_f32 v132, v76, v77
    v_cvt_pk_bf16_f32 v133, v78, v79
    ds_write_b32 v216, v132 offset:768
    ds_write_b32 v217, v133 offset:768
    v_mfma_f32_16x16x32_bf16 v[92:95], v[176:179], v[200:203], v[92:95]
    v_cvt_pk_bf16_f32 v134, v80, v81
    v_cvt_pk_bf16_f32 v135, v82, v83
    ds_write_b32 v216, v134 offset:1536
    ds_write_b32 v217, v135 offset:1536
    v_mfma_f32_16x16x32_bf16 v[96:99], v[176:179], v[204:207], v[96:99]
    v_cvt_pk_bf16_f32 v136, v84, v85
    v_cvt_pk_bf16_f32 v137, v86, v87
    ds_write_b32 v216, v136 offset:2304
    ds_write_b32 v217, v137 offset:2304
    v_mfma_f32_16x16x32_bf16 v[100:103], v[180:183], v[184:187], v[100:103]
    v_cvt_pk_bf16_f32 v138, v88, v89
    v_cvt_pk_bf16_f32 v139, v90, v91
    ds_write_b32 v216, v138 offset:3072
    ds_write_b32 v217, v139 offset:3072
    v_mfma_f32_16x16x32_bf16 v[104:107], v[180:183], v[188:191], v[104:107]
    v_cvt_pk_bf16_f32 v124, v92, v93
    v_cvt_pk_bf16_f32 v125, v94, v95
    ds_write_b32 v216, v124 offset:3840
    ds_write_b32 v217, v125 offset:3840
    v_mfma_f32_16x16x32_bf16 v[108:111], v[180:183], v[192:195], v[108:111]
    v_cvt_pk_bf16_f32 v126, v96, v97
    v_cvt_pk_bf16_f32 v127, v98, v99
    ds_write_b32 v216, v126 offset:4608
    ds_write_b32 v217, v127 offset:4608
    v_mfma_f32_16x16x32_bf16 v[112:115], v[180:183], v[196:199], v[112:115]
    v_cvt_pk_bf16_f32 v128, v100, v101
    v_cvt_pk_bf16_f32 v129, v102, v103
    ds_write_b32 v218, v128 offset:768
    ds_write_b32 v219, v129 offset:768
    v_mfma_f32_16x16x32_bf16 v[116:119], v[180:183], v[200:203], v[116:119]
    v_cvt_pk_bf16_f32 v130, v104, v105
    v_cvt_pk_bf16_f32 v131, v106, v107
    ds_write_b32 v218, v130 offset:1536
    ds_write_b32 v219, v131 offset:1536
    v_mfma_f32_16x16x32_bf16 v[120:123], v[180:183], v[204:207], v[120:123]
    v_cvt_pk_bf16_f32 v132, v108, v109
    v_cvt_pk_bf16_f32 v133, v110, v111
    ds_write_b32 v218, v132 offset:2304
    ds_write_b32 v219, v133 offset:2304
    v_cvt_pk_bf16_f32 v134, v112, v113
    v_cvt_pk_bf16_f32 v135, v114, v115
    ds_write_b32 v218, v134 offset:3072
    ds_write_b32 v219, v135 offset:3072
    v_cvt_pk_bf16_f32 v136, v116, v117
    v_cvt_pk_bf16_f32 v137, v118, v119
    ds_write_b32 v218, v136 offset:3840
    ds_write_b32 v219, v137 offset:3840
    v_cvt_pk_bf16_f32 v138, v120, v121
    v_cvt_pk_bf16_f32 v139, v122, v123
    ds_write_b32 v218, v138 offset:4608
    ds_write_b32 v219, v139 offset:4608
    s_branch a1_attn
a1_c0:
    v_add_u32 v10, v7, v8
    v_sub_u32 v11, v7, v8
    v_mov_b32 v12, v10
    v_mov_b32 v13, v10
    v_mul_u32_u24 v4, 48, v2
    v_lshlrev_b32 v5, 2, v3
    v_add_u32 v5, 0, v5
    v_mul_u32_u24 v6, 3641, v5
    v_lshrrev_b32 v6, 16, v6
    v_mul_u32_u24 v6, 5340, v6
    v_lshl_add_u32 v212, v5, 1, v6
    v_add_u32 v212, v212, v4
    v_lshlrev_b32 v5, 2, v3
    v_add_u32 v5, 2, v5
    v_mul_u32_u24 v6, 3641, v5
    v_lshrrev_b32 v6, 16, v6
    v_mul_u32_u24 v6, 5340, v6
    v_lshl_add_u32 v213, v5, 1, v6
    v_add_u32 v213, v213, v4
    v_lshlrev_b32 v5, 2, v3
    v_add_u32 v5, 16, v5
    v_mul_u32_u24 v6, 3641, v5
    v_lshrrev_b32 v6, 16, v6
    v_mul_u32_u24 v6, 5340, v6
    v_lshl_add_u32 v214, v5, 1, v6
    v_add_u32 v214, v214, v4
    v_lshlrev_b32 v5, 2, v3
    v_add_u32 v5, 18, v5
    v_mul_u32_u24 v6, 3641, v5
    v_lshrrev_b32 v6, 16, v6
    v_mul_u32_u24 v6, 5340, v6
    v_lshl_add_u32 v215, v5, 1, v6
    v_add_u32 v215, v215, v4
    v_lshlrev_b32 v5, 2, v3
    v_add_u32 v5, 32, v5
    v_mul_u32_u24 v6, 3641, v5
    v_lshrrev_b32 v6, 16, v6
    v_mul_u32_u24 v6, 5340, v6
    v_lshl_add_u32 v216, v5, 1, v6
    v_add_u32 v216, v216, v4
    v_lshlrev_b32 v5, 2, v3
    v_add_u32 v5, 34, v5
    v_mul_u32_u24 v6, 3641, v5
    v_lshrrev_b32 v6, 16, v6
    v_mul_u32_u24 v6, 5340, v6
    v_lshl_add_u32 v217, v5, 1, v6
    v_add_u32 v217, v217, v4
    v_lshlrev_b32 v5, 2, v3
    v_add_u32 v5, 208, v5
    v_mul_u32_u24 v6, 3641, v5
    v_lshrrev_b32 v6, 16, v6
    v_mul_u32_u24 v6, 5340, v6
    v_lshl_add_u32 v218, v5, 1, v6
    v_add_u32 v218, v218, v4
    v_lshlrev_b32 v5, 2, v3
    v_add_u32 v5, 210, v5
    v_mul_u32_u24 v6, 3641, v5
    v_lshrrev_b32 v6, 16, v6
    v_mul_u32_u24 v6, 5340, v6
    v_lshl_add_u32 v219, v5, 1, v6
    v_add_u32 v219, v219, v4
    v_mov_b64 v[28:29], 0
    v_mov_b64 v[30:31], 0
    v_mov_b64 v[32:33], 0
    v_mov_b64 v[34:35], 0
    v_mov_b64 v[36:37], 0
    v_mov_b64 v[38:39], 0
    v_mov_b64 v[40:41], 0
    v_mov_b64 v[42:43], 0
    v_mov_b64 v[44:45], 0
    v_mov_b64 v[46:47], 0
    v_mov_b64 v[48:49], 0
    v_mov_b64 v[50:51], 0
    v_mov_b64 v[52:53], 0
    v_mov_b64 v[54:55], 0
    v_mov_b64 v[56:57], 0
    v_mov_b64 v[58:59], 0
    v_mov_b64 v[60:61], 0
    v_mov_b64 v[62:63], 0
    v_mov_b64 v[64:65], 0
    v_mov_b64 v[66:67], 0
    v_mov_b64 v[68:69], 0
    v_mov_b64 v[70:71], 0
    v_mov_b64 v[72:73], 0
    v_mov_b64 v[74:75], 0
    v_mov_b64 v[76:77], 0
    v_mov_b64 v[78:79], 0
    v_mov_b64 v[80:81], 0
    v_mov_b64 v[82:83], 0
    v_mov_b64 v[84:85], 0
    v_mov_b64 v[86:87], 0
    v_mov_b64 v[88:89], 0
    v_mov_b64 v[90:91], 0
    v_mov_b64 v[92:93], 0
    v_mov_b64 v[94:95], 0
    v_mov_b64 v[96:97], 0
    v_mov_b64 v[98:99], 0
    v_mov_b64 v[100:101], 0
    v_mov_b64 v[102:103], 0
    v_mov_b64 v[104:105], 0
    v_mov_b64 v[106:107], 0
    v_mov_b64 v[108:109], 0
    v_mov_b64 v[110:111], 0
    v_mov_b64 v[112:113], 0
    v_mov_b64 v[114:115], 0
    v_mov_b64 v[116:117], 0
    v_mov_b64 v[118:119], 0
    s_mov_b32 s60, 0
    s_mov_b32 s61, 0
    s_mov_b32 s52, 43008
    s_mov_b32 s53, 4294881280
    s_barrier
    ds_read_b64_tr_b16 v[124:125], v10 offset:0
    ds_read_b64_tr_b16 v[126:127], v10 offset:1792
    ds_read_b64_tr_b16 v[128:129], v11 offset:32
    ds_read_b64_tr_b16 v[130:131], v11 offset:1824
    ds_read_b64_tr_b16 v[132:133], v10 offset:64
    ds_read_b64_tr_b16 v[134:135], v10 offset:1856
    ds_read_b64_tr_b16 v[136:137], v11 offset:416
    ds_read_b64_tr_b16 v[138:139], v11 offset:2208
    ds_read_b128 v[140:143], v14 offset:0
    ds_read_b128 v[144:147], v14 offset:2048
    ds_read_b128 v[148:151], v14 offset:4096
    ds_read_b128 v[152:155], v14 offset:6144
    ds_read_b128 v[156:159], v14 offset:8192
    ds_read_b128 v[160:163], v14 offset:10240
    ds_read_b128 v[164:167], v14 offset:12288
    s_waitcnt lgkmcnt(0)
    s_branch a1_q0
a1_l0:
    s_barrier
    v_mfma_f32_16x16x32_bf16 v[28:31], v[168:171], v[184:187], v[28:31]
    ds_read_b64_tr_b16 v[124:125], v10 offset:0
    v_mfma_f32_16x16x32_bf16 v[32:35], v[168:171], v[188:191], v[32:35]
    ds_read_b64_tr_b16 v[126:127], v10 offset:1792
    v_mfma_f32_16x16x32_bf16 v[36:39], v[168:171], v[192:195], v[36:39]
    ds_read_b64_tr_b16 v[128:129], v11 offset:32
    v_mfma_f32_16x16x32_bf16 v[40:43], v[168:171], v[196:199], v[40:43]
    ds_read_b64_tr_b16 v[130:131], v11 offset:1824
    v_mfma_f32_16x16x32_bf16 v[44:47], v[168:171], v[200:203], v[44:47]
    ds_read_b64_tr_b16 v[132:133], v10 offset:64
    v_mfma_f32_16x16x32_bf16 v[48:51], v[168:171], v[204:207], v[48:51]
    ds_read_b64_tr_b16 v[134:135], v10 offset:1856
    v_mfma_f32_16x16x32_bf16 v[52:55], v[168:171], v[208:211], v[52:55]
    ds_read_b64_tr_b16 v[136:137], v11 offset:416
    v_mfma_f32_16x16x32_bf16 v[56:59], v[172:175], v[184:187], v[56:59]
    ds_read_b64_tr_b16 v[138:139], v11 offset:2208
    v_mfma_f32_16x16x32_bf16 v[60:63], v[172:175], v[188:191], v[60:63]
    ds_read_b128 v[140:143], v14 offset:0
    v_mfma_f32_16x16x32_bf16 v[64:67], v[172:175], v[192:195], v[64:67]
    ds_read_b128 v[144:147], v14 offset:2048
    v_mfma_f32_16x16x32_bf16 v[68:71], v[172:175], v[196:199], v[68:71]
    ds_read_b128 v[148:151], v14 offset:4096
    v_mfma_f32_16x16x32_bf16 v[72:75], v[172:175], v[200:203], v[72:75]
    ds_read_b128 v[152:155], v14 offset:6144
    v_mfma_f32_16x16x32_bf16 v[76:79], v[172:175], v[204:207], v[76:79]
    ds_read_b128 v[156:159], v14 offset:8192
    v_mfma_f32_16x16x32_bf16 v[80:83], v[172:175], v[208:211], v[80:83]
    ds_read_b128 v[160:163], v14 offset:10240
    v_mfma_f32_16x16x32_bf16 v[84:87], v[176:179], v[184:187], v[84:87]
    ds_read_b128 v[164:167], v14 offset:12288
    v_mfma_f32_16x16x32_bf16 v[88:91], v[176:179], v[188:191], v[88:91]
    v_mfma_f32_16x16x32_bf16 v[92:95], v[176:179], v[192:195], v[92:95]
    v_mfma_f32_16x16x32_bf16 v[96:99], v[176:179], v[196:199], v[96:99]
    v_mfma_f32_16x16x32_bf16 v[100:103], v[176:179], v[200:203], v[100:103]
    v_mfma_f32_16x16x32_bf16 v[104:107], v[176:179], v[204:207], v[104:107]
    v_mfma_f32_16x16x32_bf16 v[108:111], v[176:179], v[208:211], v[108:111]
    v_mfma_f32_16x16x32_bf16 v[112:115], v[180:183], v[188:191], v[112:115]
    v_mfma_f32_16x16x32_bf16 v[116:119], v[180:183], v[192:195], v[116:119]
    s_waitcnt lgkmcnt(0)
a1_q0:
    s_cmp_lg_u32 s60, 0
    s_cbranch_scc1 lpf_5
    s_add_u32 s63, s60, 9
    s_cmp_gt_u32 s63, 8
    s_cbranch_scc1 lpf_5
    s_lshl_b32 s96, s63, 7
    s_mul_i32 s97, s63, 221184
    buffer_load_dword v240, v231, s[48:51], s97 offen
    buffer_load_dword v241, v230, s[44:47], s96 offen
lpf_5:
    s_add_u32 s61, s61, 1
    s_cmp_eq_u32 s61, 3
    s_cselect_b32 s62, s53, s52
    s_cselect_b32 s61, 0, s61
    v_mfma_f32_16x16x32_bf16 v[28:31], v[124:127], v[140:143], v[28:31]
    ds_read_b64_tr_b16 v[168:169], v10 offset:14336
    v_mfma_f32_16x16x32_bf16 v[32:35], v[124:127], v[144:147], v[32:35]
    ds_read_b64_tr_b16 v[170:171], v10 offset:16128
    v_mfma_f32_16x16x32_bf16 v[36:39], v[124:127], v[148:151], v[36:39]
    ds_read_b64_tr_b16 v[172:173], v11 offset:14368
    v_mfma_f32_16x16x32_bf16 v[40:43], v[124:127], v[152:155], v[40:43]
    ds_read_b64_tr_b16 v[174:175], v11 offset:16160
    v_mfma_f32_16x16x32_bf16 v[44:47], v[124:127], v[156:159], v[44:47]
    ds_read_b64_tr_b16 v[176:177], v10 offset:14400
    v_mfma_f32_16x16x32_bf16 v[48:51], v[124:127], v[160:163], v[48:51]
    ds_read_b64_tr_b16 v[178:179], v10 offset:16192
    v_mfma_f32_16x16x32_bf16 v[52:55], v[124:127], v[164:167], v[52:55]
    ds_read_b64_tr_b16 v[180:181], v11 offset:14752
    v_mfma_f32_16x16x32_bf16 v[56:59], v[128:131], v[140:143], v[56:59]
    ds_read_b64_tr_b16 v[182:183], v11 offset:16544
    v_mfma_f32_16x16x32_bf16 v[60:63], v[128:131], v[144:147], v[60:63]
    ds_read_b128 v[184:187], v15 offset:0
    v_mfma_f32_16x16x32_bf16 v[64:67], v[128:131], v[148:151], v[64:67]
    ds_read_b128 v[188:191], v15 offset:2048
    v_mfma_f32_16x16x32_bf16 v[68:71], v[128:131], v[152:155], v[68:71]
    ds_read_b128 v[192:195], v15 offset:4096
    v_mfma_f32_16x16x32_bf16 v[72:75], v[128:131], v[156:159], v[72:75]
    ds_read_b128 v[196:199], v15 offset:6144
    v_mfma_f32_16x16x32_bf16 v[76:79], v[128:131], v[160:163], v[76:79]
    ds_read_b128 v[200:203], v15 offset:8192
    v_mfma_f32_16x16x32_bf16 v[80:83], v[128:131], v[164:167], v[80:83]
    ds_read_b128 v[204:207], v15 offset:10240
    v_mfma_f32_16x16x32_bf16 v[84:87], v[132:135], v[140:143], v[84:87]
    ds_read_b128 v[208:211], v15 offset:12288
    v_mfma_f32_16x16x32_bf16 v[88:91], v[132:135], v[144:147], v[88:91]
    v_mfma_f32_16x16x32_bf16 v[92:95], v[132:135], v[148:151], v[92:95]
    v_mfma_f32_16x16x32_bf16 v[96:99], v[132:135], v[152:155], v[96:99]
    v_mfma_f32_16x16x32_bf16 v[100:103], v[132:135], v[156:159], v[100:103]
    v_mfma_f32_16x16x32_bf16 v[104:107], v[132:135], v[160:163], v[104:107]
    v_mfma_f32_16x16x32_bf16 v[108:111], v[132:135], v[164:167], v[108:111]
    v_mfma_f32_16x16x32_bf16 v[112:115], v[136:139], v[144:147], v[112:115]
    v_mfma_f32_16x16x32_bf16 v[116:119], v[136:139], v[148:151], v[116:119]
    v_add_u32 v10, s62, v10
    v_add_u32 v11, s62, v11
    v_add_u32 v12, s62, v12
    v_add_u32 v13, s62, v13
    v_add_u32 v14, s62, v14
    v_add_u32 v15, s62, v15
    s_add_u32 s60, s60, 1
    s_cmp_lt_u32 s60, 9
    s_waitcnt lgkmcnt(0)
    s_cbranch_scc1 a1_l0
    s_barrier
    v_mfma_f32_16x16x32_bf16 v[28:31], v[168:171], v[184:187], v[28:31]
    v_mfma_f32_16x16x32_bf16 v[32:35], v[168:171], v[188:191], v[32:35]
    v_mfma_f32_16x16x32_bf16 v[36:39], v[168:171], v[192:195], v[36:39]
    v_mfma_f32_16x16x32_bf16 v[40:43], v[168:171], v[196:199], v[40:43]
    s_nop 4
    v_cvt_pk_bf16_f32 v124, v28, v29
    v_cvt_pk_bf16_f32 v125, v30, v31
    ds_write_b32 v212, v124 offset:0
    ds_write_b32 v213, v125 offset:0
    v_mfma_f32_16x16x32_bf16 v[44:47], v[168:171], v[200:203], v[44:47]
    v_cvt_pk_bf16_f32 v126, v32, v33
    v_cvt_pk_bf16_f32 v127, v34, v35
    ds_write_b32 v212, v126 offset:768
    ds_write_b32 v213, v127 offset:768
    v_mfma_f32_16x16x32_bf16 v[48:51], v[168:171], v[204:207], v[48:51]
    v_cvt_pk_bf16_f32 v128, v36, v37
    v_cvt_pk_bf16_f32 v129, v38, v39
    ds_write_b32 v212, v128 offset:1536
    ds_write_b32 v213, v129 offset:1536
    v_mfma_f32_16x16x32_bf16 v[52:55], v[168:171], v[208:211], v[52:55]
    v_cvt_pk_bf16_f32 v130, v40, v41
    v_cvt_pk_bf16_f32 v131, v42, v43
    ds_write_b32 v212, v130 offset:2304
    ds_write_b32 v213, v131 offset:2304
    v_mfma_f32_16x16x32_bf16 v[56:59], v[172:175], v[184:187], v[56:59]
    v_cvt_pk_bf16_f32 v132, v44, v45
    v_cvt_pk_bf16_f32 v133, v46, v47
    ds_write_b32 v212, v132 offset:3072
    ds_write_b32 v213, v133 offset:3072
    v_mfma_f32_16x16x32_bf16 v[60:63], v[172:175], v[188:191], v[60:63]
    v_cvt_pk_bf16_f32 v134, v48, v49
    v_cvt_pk_bf16_f32 v135, v50, v51
    ds_write_b32 v212, v134 offset:3840
    ds_write_b32 v213, v135 offset:3840
    v_mfma_f32_16x16x32_bf16 v[64:67], v[172:175], v[192:195], v[64:67]
    v_cvt_pk_bf16_f32 v136, v52, v53
    v_cvt_pk_bf16_f32 v137, v54, v55
    ds_write_b32 v212, v136 offset:4608
    ds_write_b32 v213, v137 offset:4608
    v_mfma_f32_16x16x32_bf16 v[68:71], v[172:175], v[196:199], v[68:71]
    v_cvt_pk_bf16_f32 v138, v56, v57
    v_cvt_pk_bf16_f32 v139, v58, v59
    ds_write_b32 v214, v138 offset:0
    ds_write_b32 v215, v139 offset:0
    v_mfma_f32_16x16x32_bf16 v[72:75], v[172:175], v[200:203], v[72:75]
    v_cvt_pk_bf16_f32 v124, v60, v61
    v_cvt_pk_bf16_f32 v125, v62, v63
    ds_write_b32 v214, v124 offset:768
    ds_write_b32 v215, v125 offset:768
    v_mfma_f32_16x16x32_bf16 v[76:79], v[172:175], v[204:207], v[76:79]
    v_cvt_pk_bf16_f32 v126, v64, v65
    v_cvt_pk_bf16_f32 v127, v66, v67
    ds_write_b32 v214, v126 offset:1536
    ds_write_b32 v215, v127 offset:1536
    v_mfma_f32_16x16x32_bf16 v[80:83], v[172:175], v[208:211], v[80:83]
    v_cvt_pk_bf16_f32 v128, v68, v69
    v_cvt_pk_bf16_f32 v129, v70, v71
    ds_write_b32 v214, v128 offset:2304
    ds_write_b32 v215, v129 offset:2304
    v_mfma_f32_16x16x32_bf16 v[84:87], v[176:179], v[184:187], v[84:87]
    v_cvt_pk_bf16_f32 v130, v72, v73
    v_cvt_pk_bf16_f32 v131, v74, v75
    ds_write_b32 v214, v130 offset:3072
    ds_write_b32 v215, v131 offset:3072
    v_mfma_f32_16x16x32_bf16 v[88:91], v[176:179], v[188:191], v[88:91]
    v_cvt_pk_bf16_f32 v132, v76, v77
    v_cvt_pk_bf16_f32 v133, v78, v79
    ds_write_b32 v214, v132 offset:3840
    ds_write_b32 v215, v133 offset:3840
    v_mfma_f32_16x16x32_bf16 v[92:95], v[176:179], v[192:195], v[92:95]
    v_cvt_pk_bf16_f32 v134, v80, v81
    v_cvt_pk_bf16_f32 v135, v82, v83
    ds_write_b32 v214, v134 offset:4608
    ds_write_b32 v215, v135 offset:4608
    v_mfma_f32_16x16x32_bf16 v[96:99], v[176:179], v[196:199], v[96:99]
    v_cvt_pk_bf16_f32 v136, v84, v85
    v_cvt_pk_bf16_f32 v137, v86, v87
    ds_write_b32 v216, v136 offset:0
    ds_write_b32 v217, v137 offset:0
    v_mfma_f32_16x16x32_bf16 v[100:103], v[176:179], v[200:203], v[100:103]
    v_cvt_pk_bf16_f32 v138, v88, v89
    v_cvt_pk_bf16_f32 v139, v90, v91
    ds_write_b32 v216, v138 offset:768
    ds_write_b32 v217, v139 offset:768
    v_mfma_f32_16x16x32_bf16 v[104:107], v[176:179], v[204:207], v[104:107]
    v_cvt_pk_bf16_f32 v124, v92, v93
    v_cvt_pk_bf16_f32 v125, v94, v95
    ds_write_b32 v216, v124 offset:1536
    ds_write_b32 v217, v125 offset:1536
    v_mfma_f32_16x16x32_bf16 v[108:111], v[176:179], v[208:211], v[108:111]
    v_cvt_pk_bf16_f32 v126, v96, v97
    v_cvt_pk_bf16_f32 v127, v98, v99
    ds_write_b32 v216, v126 offset:2304
    ds_write_b32 v217, v127 offset:2304
    v_mfma_f32_16x16x32_bf16 v[112:115], v[180:183], v[188:191], v[112:115]
    v_cvt_pk_bf16_f32 v128, v100, v101
    v_cvt_pk_bf16_f32 v129, v102, v103
    ds_write_b32 v216, v128 offset:3072
    ds_write_b32 v217, v129 offset:3072
    v_mfma_f32_16x16x32_bf16 v[116:119], v[180:183], v[192:195], v[116:119]
    v_cvt_pk_bf16_f32 v130, v104, v105
    v_cvt_pk_bf16_f32 v131, v106, v107
    ds_write_b32 v216, v130 offset:3840
    ds_write_b32 v217, v131 offset:3840
    v_cvt_pk_bf16_f32 v132, v108, v109
    v_cvt_pk_bf16_f32 v133, v110, v111
    ds_write_b32 v216, v132 offset:4608
    ds_write_b32 v217, v133 offset:4608
    v_cvt_pk_bf16_f32 v134, v112, v113
    v_cvt_pk_bf16_f32 v135, v114, v115
    ds_write_b32 v218, v134 offset:768
    ds_write_b32 v219, v135 offset:768
    v_cvt_pk_bf16_f32 v136, v116, v117
    v_cvt_pk_bf16_f32 v137, v118, v119
    ds_write_b32 v218, v136 offset:1536
    ds_write_b32 v219, v137 offset:1536
    s_branch a1_attn
a1_c1:
    v_add_u32 v10, v7, v8
    v_sub_u32 v11, v7, v8
    v_mov_b32 v12, v10
    v_mov_b32 v13, v10
    v_mul_u32_u24 v4, 48, v2
    v_lshlrev_b32 v5, 2, v3
    v_add_u32 v5, 48, v5
    v_mul_u32_u24 v6, 3641, v5
    v_lshrrev_b32 v6, 16, v6
    v_mul_u32_u24 v6, 5340, v6
    v_lshl_add_u32 v212, v5, 1, v6
    v_add_u32 v212, v212, v4
    v_lshlrev_b32 v5, 2, v3
    v_add_u32 v5, 50, v5
    v_mul_u32_u24 v6, 3641, v5
    v_lshrrev_b32 v6, 16, v6
    v_mul_u32_u24 v6, 5340, v6
    v_lshl_add_u32 v213, v5, 1, v6
    v_add_u32 v213, v213, v4
    v_lshlrev_b32 v5, 2, v3
    v_add_u32 v5, 64, v5
    v_mul_u32_u24 v6, 3641, v5
    v_lshrrev_b32 v6, 16, v6
    v_mul_u32_u24 v6, 5340, v6
    v_lshl_add_u32 v214, v5, 1, v6
    v_add_u32 v214, v214, v4
    v_lshlrev_b32 v5, 2, v3
    v_add_u32 v5, 66, v5
    v_mul_u32_u24 v6, 3641, v5
    v_lshrrev_b32 v6, 16, v6
    v_mul_u32_u24 v6, 5340, v6
    v_lshl_add_u32 v215, v5, 1, v6
    v_add_u32 v215, v215, v4
    v_lshlrev_b32 v5, 2, v3
    v_add_u32 v5, 80, v5
    v_mul_u32_u24 v6, 3641, v5
    v_lshrrev_b32 v6, 16, v6
    v_mul_u32_u24 v6, 5340, v6
    v_lshl_add_u32 v216, v5, 1, v6
    v_add_u32 v216, v216, v4
    v_lshlrev_b32 v5, 2, v3
    v_add_u32 v5, 82, v5
    v_mul_u32_u24 v6, 3641, v5
    v_lshrrev_b32 v6, 16, v6
    v_mul_u32_u24 v6, 5340, v6
    v_lshl_add_u32 v217, v5, 1, v6
    v_add_u32 v217, v217, v4
    v_lshlrev_b32 v5, 2, v3
    v_add_u32 v5, 208, v5
    v_mul_u32_u24 v6, 3641, v5
    v_lshrrev_b32 v6, 16, v6
    v_mul_u32_u24 v6, 5340, v6
    v_lshl_add_u32 v218, v5, 1, v6
    v_add_u32 v218, v218, v4
    v_lshlrev_b32 v5, 2, v3
    v_add_u32 v5, 210, v5
    v_mul_u32_u24 v6, 3641, v5
    v_lshrrev_b32 v6, 16, v6
    v_mul_u32_u24 v6, 5340, v6
    v_lshl_add_u32 v219, v5, 1, v6
    v_add_u32 v219, v219, v4
    v_mov_b64 v[28:29], 0
    v_mov_b64 v[30:31], 0
    v_mov_b64 v[32:33], 0
    v_mov_b64 v[34:35], 0
    v_mov_b64 v[36:37], 0
    v_mov_b64 v[38:39], 0
    v_mov_b64 v[40:41], 0
    v_mov_b64 v[42:43], 0
    v_mov_b64 v[44:45], 0
    v_mov_b64 v[46:47], 0
    v_mov_b64 v[48:49], 0
    v_mov_b64 v[50:51], 0
    v_mov_b64 v[52:53], 0
    v_mov_b64 v[54:55], 0
    v_mov_b64 v[56:57], 0
    v_mov_b64 v[58:59], 0
    v_mov_b64 v[60:61], 0
    v_mov_b64 v[62:63], 0
    v_mov_b64 v[64:65], 0
    v_mov_b64 v[66:67], 0
    v_mov_b64 v[68:69], 0
    v_mov_b64 v[70:71], 0
    v_mov_b64 v[72:73], 0
    v_mov_b64 v[74:75], 0
    v_mov_b64 v[76:77], 0
    v_mov_b64 v[78:79], 0
    v_mov_b64 v[80:81], 0
    v_mov_b64 v[82:83], 0
    v_mov_b64 v[84:85], 0
    v_mov_b64 v[86:87], 0
    v_mov_b64 v[88:89], 0
    v_mov_b64 v[90:91], 0
    v_mov_b64 v[92:93], 0
    v_mov_b64 v[94:95], 0
    v_mov_b64 v[96:97], 0
    v_mov_b64 v[98:99], 0
    v_mov_b64 v[100:101], 0
    v_mov_b64 v[102:103], 0
    v_mov_b64 v[104:105], 0
    v_mov_b64 v[106:107], 0
    v_mov_b64 v[108:109], 0
    v_mov_b64 v[110:111], 0
    v_mov_b64 v[112:113], 0
    v_mov_b64 v[114:115], 0
    v_mov_b64 v[116:117], 0
    v_mov_b64 v[118:119], 0
    s_mov_b32 s60, 0
    s_mov_b32 s61, 0
    s_mov_b32 s52, 43008
    s_mov_b32 s53, 4294881280
    s_barrier
    ds_read_b64_tr_b16 v[124:125], v11 offset:96
    ds_read_b64_tr_b16 v[126:127], v11 offset:1888
    ds_read_b64_tr_b16 v[128:129], v10 offset:128
    ds_read_b64_tr_b16 v[130:131], v10 offset:1920
    ds_read_b64_tr_b16 v[132:133], v11 offset:160
    ds_read_b64_tr_b16 v[134:135], v11 offset:1952
    ds_read_b64_tr_b16 v[136:137], v11 offset:416
    ds_read_b64_tr_b16 v[138:139], v11 offset:2208
    ds_read_b128 v[140:143], v14 offset:0
    ds_read_b128 v[144:147], v14 offset:2048
    ds_read_b128 v[148:151], v14 offset:4096
    ds_read_b128 v[152:155], v14 offset:6144
    ds_read_b128 v[156:159], v14 offset:8192
    ds_read_b128 v[160:163], v14 offset:10240
    ds_read_b128 v[164:167], v14 offset:12288
    s_waitcnt lgkmcnt(0)
    s_branch a1_q1
a1_l1:
    s_barrier
    v_mfma_f32_16x16x32_bf16 v[28:31], v[168:171], v[184:187], v[28:31]
    ds_read_b64_tr_b16 v[124:125], v11 offset:96
    v_mfma_f32_16x16x32_bf16 v[32:35], v[168:171], v[188:191], v[32:35]
    ds_read_b64_tr_b16 v[126:127], v11 offset:1888
    v_mfma_f32_16x16x32_bf16 v[36:39], v[168:171], v[192:195], v[36:39]
    ds_read_b64_tr_b16 v[128:129], v10 offset:128
    v_mfma_f32_16x16x32_bf16 v[40:43], v[168:171], v[196:199], v[40:43]
    ds_read_b64_tr_b16 v[130:131], v10 offset:1920
    v_mfma_f32_16x16x32_bf16 v[44:47], v[168:171], v[200:203], v[44:47]
    ds_read_b64_tr_b16 v[132:133], v11 offset:160
    v_mfma_f32_16x16x32_bf16 v[48:51], v[168:171], v[204:207], v[48:51]
    ds_read_b64_tr_b16 v[134:135], v11 offset:1952
    v_mfma_f32_16x16x32_bf16 v[52:55], v[168:171], v[208:211], v[52:55]
    ds_read_b64_tr_b16 v[136:137], v11 offset:416
    v_mfma_f32_16x16x32_bf16 v[56:59], v[172:175], v[184:187], v[56:59]
    ds_read_b64_tr_b16 v[138:139], v11 offset:2208
    v_mfma_f32_16x16x32_bf16 v[60:63], v[172:175], v[188:191], v[60:63]
    ds_read_b128 v[140:143], v14 offset:0
    v_mfma_f32_16x16x32_bf16 v[64:67], v[172:175], v[192:195], v[64:67]
    ds_read_b128 v[144:147], v14 offset:2048
    v_mfma_f32_16x16x32_bf16 v[68:71], v[172:175], v[196:199], v[68:71]
    ds_read_b128 v[148:151], v14 offset:4096
    v_mfma_f32_16x16x32_bf16 v[72:75], v[172:175], v[200:203], v[72:75]
    ds_read_b128 v[152:155], v14 offset:6144
    v_mfma_f32_16x16x32_bf16 v[76:79], v[172:175], v[204:207], v[76:79]
    ds_read_b128 v[156:159], v14 offset:8192
    v_mfma_f32_16x16x32_bf16 v[80:83], v[172:175], v[208:211], v[80:83]
    ds_read_b128 v[160:163], v14 offset:10240
    v_mfma_f32_16x16x32_bf16 v[84:87], v[176:179], v[184:187], v[84:87]
    ds_read_b128 v[164:167], v14 offset:12288
    v_mfma_f32_16x16x32_bf16 v[88:91], v[176:179], v[188:191], v[88:91]
    v_mfma_f32_16x16x32_bf16 v[92:95], v[176:179], v[192:195], v[92:95]
    v_mfma_f32_16x16x32_bf16 v[96:99], v[176:179], v[196:199], v[96:99]
    v_mfma_f32_16x16x32_bf16 v[100:103], v[176:179], v[200:203], v[100:103]
    v_mfma_f32_16x16x32_bf16 v[104:107], v[176:179], v[204:207], v[104:107]
    v_mfma_f32_16x16x32_bf16 v[108:111], v[176:179], v[208:211], v[108:111]
    v_mfma_f32_16x16x32_bf16 v[112:115], v[180:183], v[196:199], v[112:115]
    v_mfma_f32_16x16x32_bf16 v[116:119], v[180:183], v[200:203], v[116:119]
    s_waitcnt lgkmcnt(0)
a1_q1:
    s_cmp_lg_u32 s60, 1
    s_cbranch_scc1 lpf_6
    s_add_u32 s63, s60, 9
    s_cmp_gt_u32 s63, 8
    s_cbranch_scc1 lpf_6
    s_lshl_b32 s96, s63, 7
    s_mul_i32 s97, s63, 221184
    buffer_load_dword v240, v231, s[48:51], s97 offen
    buffer_load_dword v241, v230, s[44:47], s96 offen
lpf_6:
    s_add_u32 s61, s61, 1
    s_cmp_eq_u32 s61, 3
    s_cselect_b32 s62, s53, s52
    s_cselect_b32 s61, 0, s61
    v_mfma_f32_16x16x32_bf16 v[28:31], v[124:127], v[140:143], v[28:31]
    ds_read_b64_tr_b16 v[168:169], v11 offset:14432
    v_mfma_f32_16x16x32_bf16 v[32:35], v[124:127], v[144:147], v[32:35]
    ds_read_b64_tr_b16 v[170:171], v11 offset:16224
    v_mfma_f32_16x16x32_bf16 v[36:39], v[124:127], v[148:151], v[36:39]
    ds_read_b64_tr_b16 v[172:173], v10 offset:14464
    v_mfma_f32_16x16x32_bf16 v[40:43], v[124:127], v[152:155], v[40:43]
    ds_read_b64_tr_b16 v[174:175], v10 offset:16256
    v_mfma_f32_16x16x32_bf16 v[44:47], v[124:127], v[156:159], v[44:47]
    ds_read_b64_tr_b16 v[176:177], v11 offset:14496
    v_mfma_f32_16x16x32_bf16 v[48:51], v[124:127], v[160:163], v[48:51]
    ds_read_b64_tr_b16 v[178:179], v11 offset:16288
    v_mfma_f32_16x16x32_bf16 v[52:55], v[124:127], v[164:167], v[52:55]
    ds_read_b64_tr_b16 v[180:181], v11 offset:14752
    v_mfma_f32_16x16x32_bf16 v[56:59], v[128:131], v[140:143], v[56:59]
    ds_read_b64_tr_b16 v[182:183], v11 offset:16544
    v_mfma_f32_16x16x32_bf16 v[60:63], v[128:131], v[144:147], v[60:63]
    ds_read_b128 v[184:187], v15 offset:0
    v_mfma_f32_16x16x32_bf16 v[64:67], v[128:131], v[148:151], v[64:67]
    ds_read_b128 v[188:191], v15 offset:2048
    v_mfma_f32_16x16x32_bf16 v[68:71], v[128:131], v[152:155], v[68:71]
    ds_read_b128 v[192:195], v15 offset:4096
    v_mfma_f32_16x16x32_bf16 v[72:75], v[128:131], v[156:159], v[72:75]
    ds_read_b128 v[196:199], v15 offset:6144
    v_mfma_f32_16x16x32_bf16 v[76:79], v[128:131], v[160:163], v[76:79]
    ds_read_b128 v[200:203], v15 offset:8192
    v_mfma_f32_16x16x32_bf16 v[80:83], v[128:131], v[164:167], v[80:83]
    ds_read_b128 v[204:207], v15 offset:10240
    v_mfma_f32_16x16x32_bf16 v[84:87], v[132:135], v[140:143], v[84:87]
    ds_read_b128 v[208:211], v15 offset:12288
    v_mfma_f32_16x16x32_bf16 v[88:91], v[132:135], v[144:147], v[88:91]
    v_mfma_f32_16x16x32_bf16 v[92:95], v[132:135], v[148:151], v[92:95]
    v_mfma_f32_16x16x32_bf16 v[96:99], v[132:135], v[152:155], v[96:99]
    v_mfma_f32_16x16x32_bf16 v[100:103], v[132:135], v[156:159], v[100:103]
    v_mfma_f32_16x16x32_bf16 v[104:107], v[132:135], v[160:163], v[104:107]
    v_mfma_f32_16x16x32_bf16 v[108:111], v[132:135], v[164:167], v[108:111]
    v_mfma_f32_16x16x32_bf16 v[112:115], v[136:139], v[152:155], v[112:115]
    v_mfma_f32_16x16x32_bf16 v[116:119], v[136:139], v[156:159], v[116:119]
    v_add_u32 v10, s62, v10
    v_add_u32 v11, s62, v11
    v_add_u32 v12, s62, v12
    v_add_u32 v13, s62, v13
    v_add_u32 v14, s62, v14
    v_add_u32 v15, s62, v15
    s_add_u32 s60, s60, 1
    s_cmp_lt_u32 s60, 9
    s_waitcnt lgkmcnt(0)
    s_cbranch_scc1 a1_l1
    s_barrier
    v_mfma_f32_16x16x32_bf16 v[28:31], v[168:171], v[184:187], v[28:31]
    v_mfma_f32_16x16x32_bf16 v[32:35], v[168:171], v[188:191], v[32:35]
    v_mfma_f32_16x16x32_bf16 v[36:39], v[168:171], v[192:195], v[36:39]
    v_mfma_f32_16x16x32_bf16 v[40:43], v[168:171], v[196:199], v[40:43]
    s_nop 4
    v_cvt_pk_bf16_f32 v124, v28, v29
    v_cvt_pk_bf16_f32 v125, v30, v31
    ds_write_b32 v212, v124 offset:0
    ds_write_b32 v213, v125 offset:0
    v_mfma_f32_16x16x32_bf16 v[44:47], v[168:171], v[200:203], v[44:47]
    v_cvt_pk_bf16_f32 v126, v32, v33
    v_cvt_pk_bf16_f32 v127, v34, v35
    ds_write_b32 v212, v126 offset:768
    ds_write_b32 v213, v127 offset:768
    v_mfma_f32_16x16x32_bf16 v[48:51], v[168:171], v[204:207], v[48:51]
    v_cvt_pk_bf16_f32 v128, v36, v37
    v_cvt_pk_bf16_f32 v129, v38, v39
    ds_write_b32 v212, v128 offset:1536
    ds_write_b32 v213, v129 offset:1536
    v_mfma_f32_16x16x32_bf16 v[52:55], v[168:171], v[208:211], v[52:55]
    v_cvt_pk_bf16_f32 v130, v40, v41
    v_cvt_pk_bf16_f32 v131, v42, v43
    ds_write_b32 v212, v130 offset:2304
    ds_write_b32 v213, v131 offset:2304
    v_mfma_f32_16x16x32_bf16 v[56:59], v[172:175], v[184:187], v[56:59]
    v_cvt_pk_bf16_f32 v132, v44, v45
    v_cvt_pk_bf16_f32 v133, v46, v47
    ds_write_b32 v212, v132 offset:3072
    ds_write_b32 v213, v133 offset:3072
    v_mfma_f32_16x16x32_bf16 v[60:63], v[172:175], v[188:191], v[60:63]
    v_cvt_pk_bf16_f32 v134, v48, v49
    v_cvt_pk_bf16_f32 v135, v50, v51
    ds_write_b32 v212, v134 offset:3840
    ds_write_b32 v213, v135 offset:3840
    v_mfma_f32_16x16x32_bf16 v[64:67], v[172:175], v[192:195], v[64:67]
    v_cvt_pk_bf16_f32 v136, v52, v53
    v_cvt_pk_bf16_f32 v137, v54, v55
    ds_write_b32 v212, v136 offset:4608
    ds_write_b32 v213, v137 offset:4608
    v_mfma_f32_16x16x32_bf16 v[68:71], v[172:175], v[196:199], v[68:71]
    v_cvt_pk_bf16_f32 v138, v56, v57
    v_cvt_pk_bf16_f32 v139, v58, v59
    ds_write_b32 v214, v138 offset:0
    ds_write_b32 v215, v139 offset:0
    v_mfma_f32_16x16x32_bf16 v[72:75], v[172:175], v[200:203], v[72:75]
    v_cvt_pk_bf16_f32 v124, v60, v61
    v_cvt_pk_bf16_f32 v125, v62, v63
    ds_write_b32 v214, v124 offset:768
    ds_write_b32 v215, v125 offset:768
    v_mfma_f32_16x16x32_bf16 v[76:79], v[172:175], v[204:207], v[76:79]
    v_cvt_pk_bf16_f32 v126, v64, v65
    v_cvt_pk_bf16_f32 v127, v66, v67
    ds_write_b32 v214, v126 offset:1536
    ds_write_b32 v215, v127 offset:1536
    v_mfma_f32_16x16x32_bf16 v[80:83], v[172:175], v[208:211], v[80:83]
    v_cvt_pk_bf16_f32 v128, v68, v69
    v_cvt_pk_bf16_f32 v129, v70, v71
    ds_write_b32 v214, v128 offset:2304
    ds_write_b32 v215, v129 offset:2304
    v_mfma_f32_16x16x32_bf16 v[84:87], v[176:179], v[184:187], v[84:87]
    v_cvt_pk_bf16_f32 v130, v72, v73
    v_cvt_pk_bf16_f32 v131, v74, v75
    ds_write_b32 v214, v130 offset:3072
    ds_write_b32 v215, v131 offset:3072
    v_mfma_f32_16x16x32_bf16 v[88:91], v[176:179], v[188:191], v[88:91]
    v_cvt_pk_bf16_f32 v132, v76, v77
    v_cvt_pk_bf16_f32 v133, v78, v79
    ds_write_b32 v214, v132 offset:3840
    ds_write_b32 v215, v133 offset:3840
    v_mfma_f32_16x16x32_bf16 v[92:95], v[176:179], v[192:195], v[92:95]
    v_cvt_pk_bf16_f32 v134, v80, v81
    v_cvt_pk_bf16_f32 v135, v82, v83
    ds_write_b32 v214, v134 offset:4608
    ds_write_b32 v215, v135 offset:4608
    v_mfma_f32_16x16x32_bf16 v[96:99], v[176:179], v[196:199], v[96:99]
    v_cvt_pk_bf16_f32 v136, v84, v85
    v_cvt_pk_bf16_f32 v137, v86, v87
    ds_write_b32 v216, v136 offset:0
    ds_write_b32 v217, v137 offset:0
    v_mfma_f32_16x16x32_bf16 v[100:103], v[176:179], v[200:203], v[100:103]
    v_cvt_pk_bf16_f32 v138, v88, v89
    v_cvt_pk_bf16_f32 v139, v90, v91
    ds_write_b32 v216, v138 offset:768
    ds_write_b32 v217, v139 offset:768
    v_mfma_f32_16x16x32_bf16 v[104:107], v[176:179], v[204:207], v[104:107]
    v_cvt_pk_bf16_f32 v124, v92, v93
    v_cvt_pk_bf16_f32 v125, v94, v95
    ds_write_b32 v216, v124 offset:1536
    ds_write_b32 v217, v125 offset:1536
    v_mfma_f32_16x16x32_bf16 v[108:111], v[176:179], v[208:211], v[108:111]
    v_cvt_pk_bf16_f32 v126, v96, v97
    v_cvt_pk_bf16_f32 v127, v98, v99
    ds_write_b32 v216, v126 offset:2304
    ds_write_b32 v217, v127 offset:2304
    v_mfma_f32_16x16x32_bf16 v[112:115], v[180:183], v[196:199], v[112:115]
    v_cvt_pk_bf16_f32 v128, v100, v101
    v_cvt_pk_bf16_f32 v129, v102, v103
    ds_write_b32 v216, v128 offset:3072
    ds_write_b32 v217, v129 offset:3072
    v_mfma_f32_16x16x32_bf16 v[116:119], v[180:183], v[200:203], v[116:119]
    v_cvt_pk_bf16_f32 v130, v104, v105
    v_cvt_pk_bf16_f32 v131, v106, v107
    ds_write_b32 v216, v130 offset:3840
    ds_write_b32 v217, v131 offset:3840
    v_cvt_pk_bf16_f32 v132, v108, v109
    v_cvt_pk_bf16_f32 v133, v110, v111
    ds_write_b32 v216, v132 offset:4608
    ds_write_b32 v217, v133 offset:4608
    v_cvt_pk_bf16_f32 v134, v112, v113
    v_cvt_pk_bf16_f32 v135, v114, v115
    ds_write_b32 v218, v134 offset:2304
    ds_write_b32 v219, v135 offset:2304
    v_cvt_pk_bf16_f32 v136, v116, v117
    v_cvt_pk_bf16_f32 v137, v118, v119
    ds_write_b32 v218, v136 offset:3072
    ds_write_b32 v219, v137 offset:3072
    s_branch a1_attn
a1_c2:
    v_add_u32 v10, v7, v8
    v_sub_u32 v11, v7, v8
    v_mov_b32 v12, v10
    v_mov_b32 v13, v10
    v_mul_u32_u24 v4, 48, v2
    v_lshlrev_b32 v5, 2, v3
    v_add_u32 v5, 96, v5
    v_mul_u32_u24 v6, 3641, v5
    v_lshrrev_b32 v6, 16, v6
    v_mul_u32_u24 v6, 5340, v6
    v_lshl_add_u32 v212, v5, 1, v6
    v_add_u32 v212, v212, v4
    v_lshlrev_b32 v5, 2, v3
    v_add_u32 v5, 98, v5
    v_mul_u32_u24 v6, 3641, v5
    v_lshrrev_b32 v6, 16, v6
    v_mul_u32_u24 v6, 5340, v6
    v_lshl_add_u32 v213, v5, 1, v6
    v_add_u32 v213, v213, v4
    v_lshlrev_b32 v5, 2, v3
    v_add_u32 v5, 112, v5
    v_mul_u32_u24 v6, 3641, v5
    v_lshrrev_b32 v6, 16, v6
    v_mul_u32_u24 v6, 5340, v6
    v_lshl_add_u32 v214, v5, 1, v6
    v_add_u32 v214, v214, v4
    v_lshlrev_b32 v5, 2, v3
    v_add_u32 v5, 114, v5
    v_mul_u32_u24 v6, 3641, v5
    v_lshrrev_b32 v6, 16, v6
    v_mul_u32_u24 v6, 5340, v6
    v_lshl_add_u32 v215, v5, 1, v6
    v_add_u32 v215, v215, v4
    v_lshlrev_b32 v5, 2, v3
    v_add_u32 v5, 128, v5
    v_mul_u32_u24 v6, 3641, v5
    v_lshrrev_b32 v6, 16, v6
    v_mul_u32_u24 v6, 5340, v6
    v_lshl_add_u32 v216, v5, 1, v6
    v_add_u32 v216, v216, v4
    v_lshlrev_b32 v5, 2, v3
    v_add_u32 v5, 130, v5
    v_mul_u32_u24 v6, 3641, v5
    v_lshrrev_b32 v6, 16, v6
    v_mul_u32_u24 v6, 5340, v6
    v_lshl_add_u32 v217, v5, 1, v6
    v_add_u32 v217, v217, v4
    v_lshlrev_b32 v5, 2, v3
    v_add_u32 v5, 208, v5
    v_mul_u32_u24 v6, 3641, v5
    v_lshrrev_b32 v6, 16, v6
    v_mul_u32_u24 v6, 5340, v6
    v_lshl_add_u32 v218, v5, 1, v6
    v_add_u32 v218, v218, v4
    v_lshlrev_b32 v5, 2, v3
    v_add_u32 v5, 210, v5
    v_mul_u32_u24 v6, 3641, v5
    v_lshrrev_b32 v6, 16, v6
    v_mul_u32_u24 v6, 5340, v6
    v_lshl_add_u32 v219, v5, 1, v6
    v_add_u32 v219, v219, v4
    v_mov_b64 v[28:29], 0
    v_mov_b64 v[30:31], 0
    v_mov_b64 v[32:33], 0
    v_mov_b64 v[34:35], 0
    v_mov_b64 v[36:37], 0
    v_mov_b64 v[38:39], 0
    v_mov_b64 v[40:41], 0
    v_mov_b64 v[42:43], 0
    v_mov_b64 v[44:45], 0
    v_mov_b64 v[46:47], 0
    v_mov_b64 v[48:49], 0
    v_mov_b64 v[50:51], 0
    v_mov_b64 v[52:53], 0
    v_mov_b64 v[54:55], 0
    v_mov_b64 v[56:57], 0
    v_mov_b64 v[58:59], 0
    v_mov_b64 v[60:61], 0
    v_mov_b64 v[62:63], 0
    v_mov_b64 v[64:65], 0
    v_mov_b64 v[66:67], 0
    v_mov_b64 v[68:69], 0
    v_mov_b64 v[70:71], 0
    v_mov_b64 v[72:73], 0
    v_mov_b64 v[74:75], 0
    v_mov_b64 v[76:77], 0
    v_mov_b64 v[78:79], 0
    v_mov_b64 v[80:81], 0
    v_mov_b64 v[82:83], 0
    v_mov_b64 v[84:85], 0
    v_mov_b64 v[86:87], 0
    v_mov_b64 v[88:89], 0
    v_mov_b64 v[90:91], 0
    v_mov_b64 v[92:93], 0
    v_mov_b64 v[94:95], 0
    v_mov_b64 v[96:97], 0
    v_mov_b64 v[98:99], 0
    v_mov_b64 v[100:101], 0
    v_mov_b64 v[102:103], 0
    v_mov_b64 v[104:105], 0
    v_mov_b64 v[106:107], 0
    v_mov_b64 v[108:109], 0
    v_mov_b64 v[110:111], 0
    v_mov_b64 v[112:113], 0
    v_mov_b64 v[114:115], 0
    v_mov_b64 v[116:117], 0
    v_mov_b64 v[118:119], 0
    s_mov_b32 s60, 0
    s_mov_b32 s61, 0
    s_mov_b32 s52, 43008
    s_mov_b32 s53, 4294881280
    s_barrier
    ds_read_b64_tr_b16 v[124:125], v10 offset:192
    ds_read_b64_tr_b16 v[126:127], v10 offset:1984
    ds_read_b64_tr_b16 v[128:129], v11 offset:224
    ds_read_b64_tr_b16 v[130:131], v11 offset:2016
    ds_read_b64_tr_b16 v[132:133], v10 offset:256
    ds_read_b64_tr_b16 v[134:135], v10 offset:2048
    ds_read_b64_tr_b16 v[136:137], v11 offset:416
    ds_read_b64_tr_b16 v[138:139], v11 offset:2208
    ds_read_b128 v[140:143], v14 offset:0
    ds_read_b128 v[144:147], v14 offset:2048
    ds_read_b128 v[148:151], v14 offset:4096
    ds_read_b128 v[152:155], v14 offset:6144
    ds_read_b128 v[156:159], v14 offset:8192
    ds_read_b128 v[160:163], v14 offset:10240
    ds_read_b128 v[164:167], v14 offset:12288
    s_waitcnt lgkmcnt(0)
    s_branch a1_q2
a1_l2:
    s_barrier
    v_mfma_f32_16x16x32_bf16 v[28:31], v[168:171], v[184:187], v[28:31]
    ds_read_b64_tr_b16 v[124:125], v10 offset:192
    v_mfma_f32_16x16x32_bf16 v[32:35], v[168:171], v[188:191], v[32:35]
    ds_read_b64_tr_b16 v[126:127], v10 offset:1984
    v_mfma_f32_16x16x32_bf16 v[36:39], v[168:171], v[192:195], v[36:39]
    ds_read_b64_tr_b16 v[128:129], v11 offset:224
    v_mfma_f32_16x16x32_bf16 v[40:43], v[168:171], v[196:199], v[40:43]
    ds_read_b64_tr_b16 v[130:131], v11 offset:2016
    v_mfma_f32_16x16x32_bf16 v[44:47], v[168:171], v[200:203], v[44:47]
    ds_read_b64_tr_b16 v[132:133], v10 offset:256
    v_mfma_f32_16x16x32_bf16 v[48:51], v[168:171], v[204:207], v[48:51]
    ds_read_b64_tr_b16 v[134:135], v10 offset:2048
    v_mfma_f32_16x16x32_bf16 v[52:55], v[168:171], v[208:211], v[52:55]
    ds_read_b64_tr_b16 v[136:137], v11 offset:416
    v_mfma_f32_16x16x32_bf16 v[56:59], v[172:175], v[184:187], v[56:59]
    ds_read_b64_tr_b16 v[138:139], v11 offset:2208
    v_mfma_f32_16x16x32_bf16 v[60:63], v[172:175], v[188:191], v[60:63]
    ds_read_b128 v[140:143], v14 offset:0
    v_mfma_f32_16x16x32_bf16 v[64:67], v[172:175], v[192:195], v[64:67]
    ds_read_b128 v[144:147], v14 offset:2048
    v_mfma_f32_16x16x32_bf16 v[68:71], v[172:175], v[196:199], v[68:71]
    ds_read_b128 v[148:151], v14 offset:4096
    v_mfma_f32_16x16x32_bf16 v[72:75], v[172:175], v[200:203], v[72:75]
    ds_read_b128 v[152:155], v14 offset:6144
    v_mfma_f32_16x16x32_bf16 v[76:79], v[172:175], v[204:207], v[76:79]
    ds_read_b128 v[156:159], v14 offset:8192
    v_mfma_f32_16x16x32_bf16 v[80:83], v[172:175], v[208:211], v[80:83]
    ds_read_b128 v[160:163], v14 offset:10240
    v_mfma_f32_16x16x32_bf16 v[84:87], v[176:179], v[184:187], v[84:87]
    ds_read_b128 v[164:167], v14 offset:12288
    v_mfma_f32_16x16x32_bf16 v[88:91], v[176:179], v[188:191], v[88:91]
    v_mfma_f32_16x16x32_bf16 v[92:95], v[176:179], v[192:195], v[92:95]
    v_mfma_f32_16x16x32_bf16 v[96:99], v[176:179], v[196:199], v[96:99]
    v_mfma_f32_16x16x32_bf16 v[100:103], v[176:179], v[200:203], v[100:103]
    v_mfma_f32_16x16x32_bf16 v[104:107], v[176:179], v[204:207], v[104:107]
    v_mfma_f32_16x16x32_bf16 v[108:111], v[176:179], v[208:211], v[108:111]
    v_mfma_f32_16x16x32_bf16 v[112:115], v[180:183], v[204:207], v[112:115]
    v_mfma_f32_16x16x32_bf16 v[116:119], v[180:183], v[208:211], v[116:119]
    s_waitcnt lgkmcnt(0)
a1_q2:
    s_cmp_lg_u32 s60, 2
    s_cbranch_scc1 lpf_7
    s_add_u32 s63, s60, 9
    s_cmp_gt_u32 s63, 8
    s_cbranch_scc1 lpf_7
    s_lshl_b32 s96, s63, 7
    s_mul_i32 s97, s63, 221184
    buffer_load_dword v240, v231, s[48:51], s97 offen
    buffer_load_dword v241, v230, s[44:47], s96 offen
lpf_7:
    s_add_u32 s61, s61, 1
    s_cmp_eq_u32 s61, 3
    s_cselect_b32 s62, s53, s52
    s_cselect_b32 s61, 0, s61
    v_mfma_f32_16x16x32_bf16 v[28:31], v[124:127], v[140:143], v[28:31]
    ds_read_b64_tr_b16 v[168:169], v10 offset:14528
    v_mfma_f32_16x16x32_bf16 v[32:35], v[124:127], v[144:147], v[32:35]
    ds_read_b64_tr_b16 v[170:171], v10 offset:16320
    v_mfma_f32_16x16x32_bf16 v[36:39], v[124:127], v[148:151], v[36:39]
    ds_read_b64_tr_b16 v[172:173], v11 offset:14560
    v_mfma_f32_16x16x32_bf16 v[40:43], v[124:127], v[152:155], v[40:43]
    ds_read_b64_tr_b16 v[174:175], v11 offset:16352
    v_mfma_f32_16x16x32_bf16 v[44:47], v[124:127], v[156:159], v[44:47]
    ds_read_b64_tr_b16 v[176:177], v10 offset:14592
    v_mfma_f32_16x16x32_bf16 v[48:51], v[124:127], v[160:163], v[48:51]
    ds_read_b64_tr_b16 v[178:179], v10 offset:16384
    v_mfma_f32_16x16x32_bf16 v[52:55], v[124:127], v[164:167], v[52:55]
    ds_read_b64_tr_b16 v[180:181], v11 offset:14752
    v_mfma_f32_16x16x32_bf16 v[56:59], v[128:131], v[140:143], v[56:59]
    ds_read_b64_tr_b16 v[182:183], v11 offset:16544
    v_mfma_f32_16x16x32_bf16 v[60:63], v[128:131], v[144:147], v[60:63]
    ds_read_b128 v[184:187], v15 offset:0
    v_mfma_f32_16x16x32_bf16 v[64:67], v[128:131], v[148:151], v[64:67]
    ds_read_b128 v[188:191], v15 offset:2048
    v_mfma_f32_16x16x32_bf16 v[68:71], v[128:131], v[152:155], v[68:71]
    ds_read_b128 v[192:195], v15 offset:4096
    v_mfma_f32_16x16x32_bf16 v[72:75], v[128:131], v[156:159], v[72:75]
    ds_read_b128 v[196:199], v15 offset:6144
    v_mfma_f32_16x16x32_bf16 v[76:79], v[128:131], v[160:163], v[76:79]
    ds_read_b128 v[200:203], v15 offset:8192
    v_mfma_f32_16x16x32_bf16 v[80:83], v[128:131], v[164:167], v[80:83]
    ds_read_b128 v[204:207], v15 offset:10240
    v_mfma_f32_16x16x32_bf16 v[84:87], v[132:135], v[140:143], v[84:87]
    ds_read_b128 v[208:211], v15 offset:12288
    v_mfma_f32_16x16x32_bf16 v[88:91], v[132:135], v[144:147], v[88:91]
    v_mfma_f32_16x16x32_bf16 v[92:95], v[132:135], v[148:151], v[92:95]
    v_mfma_f32_16x16x32_bf16 v[96:99], v[132:135], v[152:155], v[96:99]
    v_mfma_f32_16x16x32_bf16 v[100:103], v[132:135], v[156:159], v[100:103]
    v_mfma_f32_16x16x32_bf16 v[104:107], v[132:135], v[160:163], v[104:107]
    v_mfma_f32_16x16x32_bf16 v[108:111], v[132:135], v[164:167], v[108:111]
    v_mfma_f32_16x16x32_bf16 v[112:115], v[136:139], v[160:163], v[112:115]
    v_mfma_f32_16x16x32_bf16 v[116:119], v[136:139], v[164:167], v[116:119]
    v_add_u32 v10, s62, v10
    v_add_u32 v11, s62, v11
    v_add_u32 v12, s62, v12
    v_add_u32 v13, s62, v13
    v_add_u32 v14, s62, v14
    v_add_u32 v15, s62, v15
    s_add_u32 s60, s60, 1
    s_cmp_lt_u32 s60, 9
    s_waitcnt lgkmcnt(0)
    s_cbranch_scc1 a1_l2
    s_barrier
    v_mfma_f32_16x16x32_bf16 v[28:31], v[168:171], v[184:187], v[28:31]
    v_mfma_f32_16x16x32_bf16 v[32:35], v[168:171], v[188:191], v[32:35]
    v_mfma_f32_16x16x32_bf16 v[36:39], v[168:171], v[192:195], v[36:39]
    v_mfma_f32_16x16x32_bf16 v[40:43], v[168:171], v[196:199], v[40:43]
    s_nop 4
    v_cvt_pk_bf16_f32 v124, v28, v29
    v_cvt_pk_bf16_f32 v125, v30, v31
    ds_write_b32 v212, v124 offset:0
    ds_write_b32 v213, v125 offset:0
    v_mfma_f32_16x16x32_bf16 v[44:47], v[168:171], v[200:203], v[44:47]
    v_cvt_pk_bf16_f32 v126, v32, v33
    v_cvt_pk_bf16_f32 v127, v34, v35
    ds_write_b32 v212, v126 offset:768
    ds_write_b32 v213, v127 offset:768
    v_mfma_f32_16x16x32_bf16 v[48:51], v[168:171], v[204:207], v[48:51]
    v_cvt_pk_bf16_f32 v128, v36, v37
    v_cvt_pk_bf16_f32 v129, v38, v39
    ds_write_b32 v212, v128 offset:1536
    ds_write_b32 v213, v129 offset:1536
    v_mfma_f32_16x16x32_bf16 v[52:55], v[168:171], v[208:211], v[52:55]
    v_cvt_pk_bf16_f32 v130, v40, v41
    v_cvt_pk_bf16_f32 v131, v42, v43
    ds_write_b32 v212, v130 offset:2304
    ds_write_b32 v213, v131 offset:2304
    v_mfma_f32_16x16x32_bf16 v[56:59], v[172:175], v[184:187], v[56:59]
    v_cvt_pk_bf16_f32 v132, v44, v45
    v_cvt_pk_bf16_f32 v133, v46, v47
    ds_write_b32 v212, v132 offset:3072
    ds_write_b32 v213, v133 offset:3072
    v_mfma_f32_16x16x32_bf16 v[60:63], v[172:175], v[188:191], v[60:63]
    v_cvt_pk_bf16_f32 v134, v48, v49
    v_cvt_pk_bf16_f32 v135, v50, v51
    ds_write_b32 v212, v134 offset:3840
    ds_write_b32 v213, v135 offset:3840
    v_mfma_f32_16x16x32_bf16 v[64:67], v[172:175], v[192:195], v[64:67]
    v_cvt_pk_bf16_f32 v136, v52, v53
    v_cvt_pk_bf16_f32 v137, v54, v55
    ds_write_b32 v212, v136 offset:4608
    ds_write_b32 v213, v137 offset:4608
    v_mfma_f32_16x16x32_bf16 v[68:71], v[172:175], v[196:199], v[68:71]
    v_cvt_pk_bf16_f32 v138, v56, v57
    v_cvt_pk_bf16_f32 v139, v58, v59
    ds_write_b32 v214, v138 offset:0
    ds_write_b32 v215, v139 offset:0
    v_mfma_f32_16x16x32_bf16 v[72:75], v[172:175], v[200:203], v[72:75]
    v_cvt_pk_bf16_f32 v124, v60, v61
    v_cvt_pk_bf16_f32 v125, v62, v63
    ds_write_b32 v214, v124 offset:768
    ds_write_b32 v215, v125 offset:768
    v_mfma_f32_16x16x32_bf16 v[76:79], v[172:175], v[204:207], v[76:79]
    v_cvt_pk_bf16_f32 v126, v64, v65
    v_cvt_pk_bf16_f32 v127, v66, v67
    ds_write_b32 v214, v126 offset:1536
    ds_write_b32 v215, v127 offset:1536
    v_mfma_f32_16x16x32_bf16 v[80:83], v[172:175], v[208:211], v[80:83]
    v_cvt_pk_bf16_f32 v128, v68, v69
    v_cvt_pk_bf16_f32 v129, v70, v71
    ds_write_b32 v214, v128 offset:2304
    ds_write_b32 v215, v129 offset:2304
    v_mfma_f32_16x16x32_bf16 v[84:87], v[176:179], v[184:187], v[84:87]
    v_cvt_pk_bf16_f32 v130, v72, v73
    v_cvt_pk_bf16_f32 v131, v74, v75
    ds_write_b32 v214, v130 offset:3072
    ds_write_b32 v215, v131 offset:3072
    v_mfma_f32_16x16x32_bf16 v[88:91], v[176:179], v[188:191], v[88:91]
    v_cvt_pk_bf16_f32 v132, v76, v77
    v_cvt_pk_bf16_f32 v133, v78, v79
    ds_write_b32 v214, v132 offset:3840
    ds_write_b32 v215, v133 offset:3840
    v_mfma_f32_16x16x32_bf16 v[92:95], v[176:179], v[192:195], v[92:95]
    v_cvt_pk_bf16_f32 v134, v80, v81
    v_cvt_pk_bf16_f32 v135, v82, v83
    ds_write_b32 v214, v134 offset:4608
    ds_write_b32 v215, v135 offset:4608
    v_mfma_f32_16x16x32_bf16 v[96:99], v[176:179], v[196:199], v[96:99]
    v_cvt_pk_bf16_f32 v136, v84, v85
    v_cvt_pk_bf16_f32 v137, v86, v87
    ds_write_b32 v216, v136 offset:0
    ds_write_b32 v217, v137 offset:0
    v_mfma_f32_16x16x32_bf16 v[100:103], v[176:179], v[200:203], v[100:103]
    v_cvt_pk_bf16_f32 v138, v88, v89
    v_cvt_pk_bf16_f32 v139, v90, v91
    ds_write_b32 v216, v138 offset:768
    ds_write_b32 v217, v139 offset:768
    v_mfma_f32_16x16x32_bf16 v[104:107], v[176:179], v[204:207], v[104:107]
    v_cvt_pk_bf16_f32 v124, v92, v93
    v_cvt_pk_bf16_f32 v125, v94, v95
    ds_write_b32 v216, v124 offset:1536
    ds_write_b32 v217, v125 offset:1536
    v_mfma_f32_16x16x32_bf16 v[108:111], v[176:179], v[208:211], v[108:111]
    v_cvt_pk_bf16_f32 v126, v96, v97
    v_cvt_pk_bf16_f32 v127, v98, v99
    ds_write_b32 v216, v126 offset:2304
    ds_write_b32 v217, v127 offset:2304
    v_mfma_f32_16x16x32_bf16 v[112:115], v[180:183], v[204:207], v[112:115]
    v_cvt_pk_bf16_f32 v128, v100, v101
    v_cvt_pk_bf16_f32 v129, v102, v103
    ds_write_b32 v216, v128 offset:3072
    ds_write_b32 v217, v129 offset:3072
    v_mfma_f32_16x16x32_bf16 v[116:119], v[180:183], v[208:211], v[116:119]
    v_cvt_pk_bf16_f32 v130, v104, v105
    v_cvt_pk_bf16_f32 v131, v106, v107
    ds_write_b32 v216, v130 offset:3840
    ds_write_b32 v217, v131 offset:3840
    v_cvt_pk_bf16_f32 v132, v108, v109
    v_cvt_pk_bf16_f32 v133, v110, v111
    ds_write_b32 v216, v132 offset:4608
    ds_write_b32 v217, v133 offset:4608
    v_cvt_pk_bf16_f32 v134, v112, v113
    v_cvt_pk_bf16_f32 v135, v114, v115
    ds_write_b32 v218, v134 offset:3840
    ds_write_b32 v219, v135 offset:3840
    v_cvt_pk_bf16_f32 v136, v116, v117
    v_cvt_pk_bf16_f32 v137, v118, v119
    ds_write_b32 v218, v136 offset:4608
    ds_write_b32 v219, v137 offset:4608
    s_branch a1_attn
a1_loader:
    s_setprio 3
    s_sub_u32 s35, s29, 4
    v_lshrrev_b32 v2, 3, v1
    v_and_b32 v3, 7, v1
    v_lshrrev_b32 v4, 4, v1
    v_mul_u32_u24 v5, 1152, v2
    v_xor_b32 v6, v3, v4
    v_lshl_add_u32 v10, v6, 4, v5
    v_xor_b32 v11, 64, v10
    s_lshl_b32 s36, s35, 2
    s_cmp_eq_u32 s35, 3
    s_cselect_b32 s36, 11, s36
    s_cselect_b64 s[54:55], -1, 0
    v_cndmask_b32 v16, v10, v11, s[54:55]
    v_cndmask_b32 v17, v11, v10, s[54:55]
    s_sub_u32 s37, s34, 16
    s_mul_i32 s37, s37, 1152
    s_mul_i32 s38, s36, 9216
    s_add_u32 s37, s37, s38
    s_lshl_b32 s38, s36, 10
    s_mov_b32 s61, 0
    s_mul_i32 s62, s61, 43008
    s_add_u32 s63, s38, s62
    s_add_u32 m0, s63, 0
    s_add_u32 s52, s37, 0
    s_cmp_lt_i32 s52, 0
    s_cselect_b32 s52, 0x7fff0000, s52
    buffer_load_dwordx4 v16, s[44:47], s52 offen lds
    s_add_u32 m0, s63, 1024
    s_add_u32 s52, s37, 9216
    s_cmp_lt_i32 s52, 0
    s_cselect_b32 s52, 0x7fff0000, s52
    buffer_load_dwordx4 v17, s[44:47], s52 offen lds
    s_add_u32 m0, s63, 2048
    s_add_u32 s52, s37, 18432
    buffer_load_dwordx4 v16, s[44:47], s52 offen lds
    s_cmp_ge_u32 s35, 2
    s_cbranch_scc1 a1_sk_8
    s_add_u32 m0, s63, 3072
    s_add_u32 s52, s37, 27648
    buffer_load_dwordx4 v17, s[44:47], s52 offen lds
a1_sk_8:
    s_mul_i32 s40, s35, 448
    s_mul_i32 s41, s33, 144
    v_mov_b32 v9, 0x7fff0000
    s_add_u32 s52, s40, 0
    v_add_u32 v2, s52, v1
    v_mul_u32_u24 v3, 2341, v2
    v_lshrrev_b32 v3, 16, v3
    v_mul_u32_u24 v4, 28, v3
    v_sub_u32 v4, v2, v4
    v_bfe_u32 v5, v3, 3, 1
    v_lshlrev_b32 v5, 1, v5
    v_xor_b32 v4, v4, v5
    v_mov_b32 v6, 1152
    v_mov_b32 v7, 2160
    v_cmp_le_u32 vcc, 9, v4
    s_nop 1
    v_cndmask_b32 v6, v6, v7, vcc
    v_mov_b32 v7, -288
    v_cmp_le_u32 vcc, 18, v4
    s_nop 1
    v_cndmask_b32 v6, v6, v7, vcc
    v_lshl_add_u32 v6, v4, 4, v6
    v_add_u32 v6, s41, v6
    v_mul_u32_u24 v3, 3456, v3
    v_add_u32 v32, v3, v6
    v_cmp_eq_u32 vcc, 27, v4
    s_nop 1
    v_cndmask_b32 v32, v32, v9, vcc
    s_add_u32 s52, s40, 64
    v_add_u32 v2, s52, v1
    v_mul_u32_u24 v3, 2341, v2
    v_lshrrev_b32 v3, 16, v3
    v_mul_u32_u24 v4, 28, v3
    v_sub_u32 v4, v2, v4
    v_bfe_u32 v5, v3, 3, 1
    v_lshlrev_b32 v5, 1, v5
    v_xor_b32 v4, v4, v5
    v_mov_b32 v6, 1152
    v_mov_b32 v7, 2160
    v_cmp_le_u32 vcc, 9, v4
    s_nop 1
    v_cndmask_b32 v6, v6, v7, vcc
    v_mov_b32 v7, -288
    v_cmp_le_u32 vcc, 18, v4
    s_nop 1
    v_cndmask_b32 v6, v6, v7, vcc
    v_lshl_add_u32 v6, v4, 4, v6
    v_add_u32 v6, s41, v6
    v_mul_u32_u24 v3, 3456, v3
    v_add_u32 v33, v3, v6
    v_cmp_eq_u32 vcc, 27, v4
    s_nop 1
    v_cndmask_b32 v33, v33, v9, vcc
    s_add_u32 s52, s40, 128
    v_add_u32 v2, s52, v1
    v_mul_u32_u24 v3, 2341, v2
    v_lshrrev_b32 v3, 16, v3
    v_mul_u32_u24 v4, 28, v3
    v_sub_u32 v4, v2, v4
    v_bfe_u32 v5, v3, 3, 1
    v_lshlrev_b32 v5, 1, v5
    v_xor_b32 v4, v4, v5
    v_mov_b32 v6, 1152
    v_mov_b32 v7, 2160
    v_cmp_le_u32 vcc, 9, v4
    s_nop 1
    v_cndmask_b32 v6, v6, v7, vcc
    v_mov_b32 v7, -288
    v_cmp_le_u32 vcc, 18, v4
    s_nop 1
    v_cndmask_b32 v6, v6, v7, vcc
    v_lshl_add_u32 v6, v4, 4, v6
    v_add_u32 v6, s41, v6
    v_mul_u32_u24 v3, 3456, v3
    v_add_u32 v34, v3, v6
    v_cmp_eq_u32 vcc, 27, v4
    s_nop 1
    v_cndmask_b32 v34, v34, v9, vcc
    s_add_u32 s52, s40, 192
    v_add_u32 v2, s52, v1
    v_mul_u32_u24 v3, 2341, v2
    v_lshrrev_b32 v3, 16, v3
    v_mul_u32_u24 v4, 28, v3
    v_sub_u32 v4, v2, v4
    v_bfe_u32 v5, v3, 3, 1
    v_lshlrev_b32 v5, 1, v5
    v_xor_b32 v4, v4, v5
    v_mov_b32 v6, 1152
    v_mov_b32 v7, 2160
    v_cmp_le_u32 vcc, 9, v4
    s_nop 1
    v_cndmask_b32 v6, v6, v7, vcc
    v_mov_b32 v7, -288
    v_cmp_le_u32 vcc, 18, v4
    s_nop 1
    v_cndmask_b32 v6, v6, v7, vcc
    v_lshl_add_u32 v6, v4, 4, v6
    v_add_u32 v6, s41, v6
    v_mul_u32_u24 v3, 3456, v3
    v_add_u32 v35, v3, v6
    v_cmp_eq_u32 vcc, 27, v4
    s_nop 1
    v_cndmask_b32 v35, v35, v9, vcc
    s_add_u32 s52, s40, 256
    v_add_u32 v2, s52, v1
    v_mul_u32_u24 v3, 2341, v2
    v_lshrrev_b32 v3, 16, v3
    v_mul_u32_u24 v4, 28, v3
    v_sub_u32 v4, v2, v4
    v_bfe_u32 v5, v3, 3, 1
    v_lshlrev_b32 v5, 1, v5
    v_xor_b32 v4, v4, v5
    v_mov_b32 v6, 1152
    v_mov_b32 v7, 2160
    v_cmp_le_u32 vcc, 9, v4
    s_nop 1
    v_cndmask_b32 v6, v6, v7, vcc
    v_mov_b32 v7, -288
    v_cmp_le_u32 vcc, 18, v4
    s_nop 1
    v_cndmask_b32 v6, v6, v7, vcc
    v_lshl_add_u32 v6, v4, 4, v6
    v_add_u32 v6, s41, v6
    v_mul_u32_u24 v3, 3456, v3
    v_add_u32 v36, v3, v6
    v_cmp_eq_u32 vcc, 27, v4
    s_nop 1
    v_cndmask_b32 v36, v36, v9, vcc
    s_add_u32 s52, s40, 320
    v_add_u32 v2, s52, v1
    v_mul_u32_u24 v3, 2341, v2
    v_lshrrev_b32 v3, 16, v3
    v_mul_u32_u24 v4, 28, v3
    v_sub_u32 v4, v2, v4
    v_bfe_u32 v5, v3, 3, 1
    v_lshlrev_b32 v5, 1, v5
    v_xor_b32 v4, v4, v5
    v_mov_b32 v6, 1152
    v_mov_b32 v7, 2160
    v_cmp_le_u32 vcc, 9, v4
    s_nop 1
    v_cndmask_b32 v6, v6, v7, vcc
    v_mov_b32 v7, -288
    v_cmp_le_u32 vcc, 18, v4
    s_nop 1
    v_cndmask_b32 v6, v6, v7, vcc
    v_lshl_add_u32 v6, v4, 4, v6
    v_add_u32 v6, s41, v6
    v_mul_u32_u24 v3, 3456, v3
    v_add_u32 v37, v3, v6
    v_cmp_eq_u32 vcc, 27, v4
    s_nop 1
    v_cndmask_b32 v37, v37, v9, vcc
    s_add_u32 s52, s40, 384
    v_add_u32 v2, s52, v1
    v_mul_u32_u24 v3, 2341, v2
    v_lshrrev_b32 v3, 16, v3
    v_mul_u32_u24 v4, 28, v3
    v_sub_u32 v4, v2, v4
    v_bfe_u32 v5, v3, 3, 1
    v_lshlrev_b32 v5, 1, v5
    v_xor_b32 v4, v4, v5
    v_mov_b32 v6, 1152
    v_mov_b32 v7, 2160
    v_cmp_le_u32 vcc, 9, v4
    s_nop 1
    v_cndmask_b32 v6, v6, v7, vcc
    v_mov_b32 v7, -288
    v_cmp_le_u32 vcc, 18, v4
    s_nop 1
    v_cndmask_b32 v6, v6, v7, vcc
    v_lshl_add_u32 v6, v4, 4, v6
    v_add_u32 v6, s41, v6
    v_mul_u32_u24 v3, 3456, v3
    v_add_u32 v38, v3, v6
    v_cmp_eq_u32 vcc, 27, v4
    s_nop 1
    v_cndmask_b32 v38, v38, v9, vcc
    s_mov_b32 s40, 0
    s_mul_i32 s41, s35, 7168
    s_add_u32 s41, s41, 14336
    s_mov_b32 s62, s41
    s_add_u32 m0, s62, 0
    s_nop 0
    buffer_load_dwordx4 v32, s[48:51], s40 offen lds
    s_add_u32 m0, s62, 1024
    s_nop 0
    buffer_load_dwordx4 v33, s[48:51], s40 offen lds
    s_add_u32 m0, s62, 2048
    s_nop 0
    buffer_load_dwordx4 v34, s[48:51], s40 offen lds
    s_add_u32 m0, s62, 3072
    s_nop 0
    buffer_load_dwordx4 v35, s[48:51], s40 offen lds
    s_add_u32 m0, s62, 4096
    s_nop 0
    buffer_load_dwordx4 v36, s[48:51], s40 offen lds
    s_add_u32 m0, s62, 5120
    s_nop 0
    buffer_load_dwordx4 v37, s[48:51], s40 offen lds
    s_add_u32 m0, s62, 6144
    s_nop 0
    buffer_load_dwordx4 v38, s[48:51], s40 offen lds
    s_add_u32 s37, s37, 128
    s_add_u32 s40, s40, 221184
    s_add_u32 s61, s61, 1
    s_cmp_eq_u32 s61, 3
    s_cselect_b32 s61, 0, s61
    v_and_b32 v2, 15, v1
    v_lshrrev_b32 v3, 4, v1
    s_and_b32 s56, s29, 3
    s_lshr_b32 s57, s29, 2
    s_mul_i32 s57, s57, 3
    v_lshlrev_b32 v4, 2, v3
    v_sub_u32 v4, v2, v4
    v_add_u32 v5, 16, v4
    v_and_b32 v5, 0xfffffff1, v5
    v_cmp_eq_u32 s[64:65], 0, v5
    v_add_u32 v5, 15, v4
    v_and_b32 v5, 0xfffffff1, v5
    v_cmp_eq_u32 s[66:67], 0, v5
    v_add_u32 v5, 14, v4
    v_and_b32 v5, 0xfffffff1, v5
    v_cmp_eq_u32 s[68:69], 0, v5
    v_add_u32 v5, 13, v4
    v_and_b32 v5, 0xfffffff1, v5
    v_cmp_eq_u32 s[70:71], 0, v5
    v_add_u32 v5, 0, v4
    v_and_b32 v5, 0xfffffff1, v5
    v_cmp_eq_u32 s[72:73], 0, v5
    v_subrev_u32 v5, 1, v4
    v_and_b32 v5, 0xfffffff1, v5
    v_cmp_eq_u32 s[74:75], 0, v5
    v_subrev_u32 v5, 2, v4
    v_and_b32 v5, 0xfffffff1, v5
    v_cmp_eq_u32 s[76:77], 0, v5
    v_subrev_u32 v5, 3, v4
    v_and_b32 v5, 0xfffffff1, v5
    v_cmp_eq_u32 s[78:79], 0, v5
    v_cmp_gt_u32 s[80:81], 2, v3
    v_cmp_gt_u32 s[82:83], 3, v3
    s_or_b32 s58, s32, s57
    s_cmp_eq_u32 s58, 0
    s_cselect_b64 s[84:85], 0, s[64:65]
    s_cmp_eq_u32 s58, 0
    s_cselect_b64 s[86:87], 0, s[66:67]
    s_cmp_eq_u32 s58, 0
    s_cselect_b64 s[88:89], 0, s[68:69]
    s_cmp_eq_u32 s58, 0
    s_cselect_b64 s[90:91], 0, s[70:71]
    v_min_u32 v5, 2, v3
    v_mul_u32_u24 v6, 48, v2
    v_lshl_add_u32 v6, v5, 4, v6
    s_mul_i32 s58, s56, 5376
    s_mul_i32 s59, s57, 768
    s_add_u32 s58, s58, s59
    v_add_u32 v220, s58, v6
    v_lshrrev_b32 v5, 2, v2
    v_lshl_add_u32 v5, v3, 2, v5
    v_mul_u32_u24 v5, 48, v5
    v_and_b32 v6, 3, v2
    v_lshl_add_u32 v5, v6, 3, v5
    v_add_u32 v221, s58, v5
    v_mul_u32_u24 v5, 144, v2
    v_lshl_add_u32 v5, v3, 3, v5
    s_mul_i32 s58, s56, 36
    s_mul_i32 s59, s57, 2304
    s_add_u32 s58, s58, s59
    s_add_u32 s58, s58, 69888
    v_add_u32 v222, s58, v5
    v_add_u32 v223, 2304, v222
    v_add_u32 v224, 4608, v222
    v_mov_b32 v225, 0xff800000
    s_mul_i32 s58, s32, 110592
    s_mul_i32 s59, s33, 2304
    s_add_u32 s58, s58, s59
    v_add_u32 v4, 0, v0
    v_and_b32 v5, 15, v4
    v_lshrrev_b32 v6, 4, v4
    v_mul_u32_u24 v7, 7282, v6
    v_lshrrev_b32 v7, 16, v7
    v_mul_u32_u24 v8, 9, v7
    v_sub_u32 v6, v6, v8
    v_lshl_add_u32 v8, v7, 4, v5
    v_mul_u32_u24 v8, 144, v8
    v_lshl_add_u32 v8, v6, 4, v8
    v_add_u32 v228, 69888, v8
    v_mul_u32_u24 v7, 18432, v7
    v_lshl_add_u32 v7, v6, 8, v7
    v_lshl_add_u32 v7, v5, 4, v7
    v_add_u32 v226, s58, v7
    v_add_u32 v4, 512, v0
    v_and_b32 v5, 15, v4
    v_lshrrev_b32 v6, 4, v4
    v_mul_u32_u24 v7, 7282, v6
    v_lshrrev_b32 v7, 16, v7
    v_mul_u32_u24 v8, 9, v7
    v_sub_u32 v6, v6, v8
    v_lshl_add_u32 v8, v7, 4, v5
    v_mul_u32_u24 v8, 144, v8
    v_lshl_add_u32 v8, v6, 4, v8
    v_add_u32 v229, 69888, v8
    v_mul_u32_u24 v7, 18432, v7
    v_lshl_add_u32 v7, v6, 8, v7
    v_lshl_add_u32 v7, v5, 4, v7
    v_add_u32 v227, s58, v7
    v_mov_b32 v5, 0x7fff0000
    v_cmp_gt_u32 vcc, 864, v4
    s_nop 1
    v_cndmask_b32 v227, v5, v227, vcc
    s_waitcnt vmcnt(0)
    s_barrier
    s_mov_b32 s60, 0
a1_lp:
    s_mul_i32 s62, s61, 43008
    s_add_u32 s63, s38, s62
    s_add_u32 s62, s41, s62
    s_add_u32 m0, s63, 0
    s_add_u32 s52, s37, 0
    s_cmp_lt_i32 s52, 0
    s_cselect_b32 s52, 0x7fff0000, s52
    buffer_load_dwordx4 v16, s[44:47], s52 offen lds
    s_add_u32 m0, s63, 1024
    s_add_u32 s52, s37, 9216
    s_cmp_lt_i32 s52, 0
    s_cselect_b32 s52, 0x7fff0000, s52
    buffer_load_dwordx4 v17, s[44:47], s52 offen lds
    s_add_u32 m0, s63, 2048
    s_add_u32 s52, s37, 18432
    buffer_load_dwordx4 v16, s[44:47], s52 offen lds
    s_cmp_ge_u32 s35, 2
    s_cbranch_scc1 a1_sk_9
    s_add_u32 m0, s63, 3072
    s_add_u32 s52, s37, 27648
    buffer_load_dwordx4 v17, s[44:47], s52 offen lds
a1_sk_9:
    s_add_u32 m0, s62, 0
    s_nop 0
    buffer_load_dwordx4 v32, s[48:51], s40 offen lds
    s_add_u32 m0, s62, 1024
    s_nop 0
    buffer_load_dwordx4 v33, s[48:51], s40 offen lds
    s_add_u32 m0, s62, 2048
    s_nop 0
    buffer_load_dwordx4 v34, s[48:51], s40 offen lds
    s_add_u32 m0, s62, 3072
    s_nop 0
    buffer_load_dwordx4 v35, s[48:51], s40 offen lds
    s_add_u32 m0, s62, 4096
    s_nop 0
    buffer_load_dwordx4 v36, s[48:51], s40 offen lds
    s_add_u32 m0, s62, 5120
    s_nop 0
    buffer_load_dwordx4 v37, s[48:51], s40 offen lds
    s_add_u32 m0, s62, 6144
    s_nop 0
    buffer_load_dwordx4 v38, s[48:51], s40 offen lds
    s_add_u32 s37, s37, 128
    s_add_u32 s40, s40, 221184
    s_add_u32 s61, s61, 1
    s_cmp_eq_u32 s61, 3
    s_cselect_b32 s61, 0, s61
    s_add_u32 s60, s60, 1
    s_cmp_lt_u32 s60, 2
    s_cbranch_scc1 a1_lp
    s_mov_b32 s60, 0
a1_ll:
    s_waitcnt vmcnt(10)
    s_barrier
    s_mul_i32 s62, s61, 43008
    s_add_u32 s63, s38, s62
    s_add_u32 s62, s41, s62
    s_add_u32 m0, s63, 0
    s_add_u32 s52, s37, 0
    s_cmp_lt_i32 s52, 0
    s_cselect_b32 s52, 0x7fff0000, s52
    buffer_load_dwordx4 v16, s[44:47], s52 offen lds
    s_add_u32 m0, s63, 1024
    s_add_u32 s52, s37, 9216
    s_cmp_lt_i32 s52, 0
    s_cselect_b32 s52, 0x7fff0000, s52
    buffer_load_dwordx4 v17, s[44:47], s52 offen lds
    s_add_u32 m0, s63, 2048
    s_add_u32 s52, s37, 18432
    buffer_load_dwordx4 v16, s[44:47], s52 offen lds
    s_cmp_ge_u32 s35, 2
    s_cbranch_scc1 a1_sk_10
    s_add_u32 m0, s63, 3072
    s_add_u32 s52, s37, 27648
    buffer_load_dwordx4 v17, s[44:47], s52 offen lds
a1_sk_10:
    s_add_u32 m0, s62, 0
    s_nop 0
    buffer_load_dwordx4 v32, s[48:51], s40 offen lds
    s_add_u32 m0, s62, 1024
    s_nop 0
    buffer_load_dwordx4 v33, s[48:51], s40 offen lds
    s_add_u32 m0, s62, 2048
    s_nop 0
    buffer_load_dwordx4 v34, s[48:51], s40 offen lds
    s_add_u32 m0, s62, 3072
    s_nop 0
    buffer_load_dwordx4 v35, s[48:51], s40 offen lds
    s_add_u32 m0, s62, 4096
    s_nop 0
    buffer_load_dwordx4 v36, s[48:51], s40 offen lds
    s_add_u32 m0, s62, 5120
    s_nop 0
    buffer_load_dwordx4 v37, s[48:51], s40 offen lds
    s_add_u32 m0, s62, 6144
    s_nop 0
    buffer_load_dwordx4 v38, s[48:51], s40 offen lds
    s_add_u32 s37, s37, 128
    s_add_u32 s40, s40, 221184
    s_add_u32 s61, s61, 1
    s_cmp_eq_u32 s61, 3
    s_cselect_b32 s61, 0, s61
    s_add_u32 s60, s60, 1
    s_cmp_lt_u32 s60, 6
    s_cbranch_scc1 a1_ll
    s_waitcnt vmcnt(10)
    s_barrier
    s_waitcnt vmcnt(0)
    s_barrier
    s_barrier
a1_attn:
    s_setprio 0
    s_waitcnt lgkmcnt(0)
    s_barrier
    s_cmp_ge_u32 s2, 64
    s_cbranch_scc1 hea_11
    s_and_b32 s38, s2, 7
    s_lshr_b32 s37, s2, 3
    s_add_u32 s37, s37, 10
    s_lshl_b32 s36, s38, 4
    s_add_u32 s36, s36, s37
    s_lshl_b32 s39, s38, 1
    s_add_u32 s39, s39, s37
    s_add_u32 s39, s39, 112
    s_cmp_lt_u32 s37, 16
    s_cselect_b32 s36, s36, s39
    s_and_b32 s37, s29, 3
    s_lshl_b32 s36, s36, 2
    s_add_u32 s36, s36, s37
    s_lshl_b32 s36, s36, 12
    s_add_u32 s48, s18, s36
    s_addc_u32 s49, s19, 0
    s_and_b32 s49, s49, 0xffff
    s_mov_b32 s50, 4096
    s_mov_b32 s51, 0x00020000
    v_lshlrev_b32 v196, 4, v1
    s_lshr_b32 s37, s29, 2
    s_lshl_b32 s37, s37, 11
    v_add_u32 v196, s37, v196
    v_add_u32 v197, 4, v196
    v_add_u32 v198, 8, v196
    buffer_load_dwordx4 v[170:173], v196, s[48:51], 0 offen offset:0
    buffer_load_dwordx4 v[174:177], v197, s[48:51], 0 offen offset:0
    buffer_load_dwordx4 v[178:181], v198, s[48:51], 0 offen offset:0
    buffer_load_dwordx4 v[182:185], v196, s[48:51], 0 offen offset:1024
    buffer_load_dwordx4 v[186:189], v197, s[48:51], 0 offen offset:1024
    buffer_load_dwordx4 v[190:193], v198, s[48:51], 0 offen offset:1024
    v_mov_b32 v199, 0
    buffer_load_dwordx2 v[194:195], v199, s[48:51], 0 offen
hea_11:
    s_mov_b32 s42, 0x3eae1a93
    ds_read_b128 v[24:27], v220 offset:43776
    ds_read_b128 v[28:31], v220 offset:0
    ds_read_b128 v[32:35], v220 offset:768
    ds_read_b128 v[64:67], v220 offset:44544
    ds_read_b128 v[68:71], v220 offset:768
    ds_read_b128 v[72:75], v220 offset:1536
    ds_read_b128 v[104:107], v220 offset:45312
    ds_read_b128 v[108:111], v220 offset:1536
    ds_read_b128 v[112:115], v220 offset:2304
    ds_read_b64_tr_b16 v[36:37], v221 offset:21504
    ds_read_b64_tr_b16 v[38:39], v221 offset:22272
    ds_read_b64_tr_b16 v[40:41], v221 offset:21536
    ds_read_b64_tr_b16 v[42:43], v221 offset:22304
    ds_read_b64_tr_b16 v[76:77], v221 offset:22272
    ds_read_b64_tr_b16 v[78:79], v221 offset:23040
    ds_read_b64_tr_b16 v[80:81], v221 offset:22304
    ds_read_b64_tr_b16 v[82:83], v221 offset:23072
    ds_read_b64_tr_b16 v[116:117], v221 offset:23040
    ds_read_b64_tr_b16 v[118:119], v221 offset:23808
    ds_read_b64_tr_b16 v[120:121], v221 offset:23072
    ds_read_b64_tr_b16 v[122:123], v221 offset:23840
    s_waitcnt lgkmcnt(15)
    v_cndmask_b32 v24, 0, v24, s[82:83]
    v_cndmask_b32 v25, 0, v25, s[80:81]
    v_cndmask_b32 v26, 0, v26, s[80:81]
    v_cndmask_b32 v27, 0, v27, s[80:81]
    s_nop 1
    v_mfma_f32_16x16x32_bf16 v[44:47], v[28:31], v[24:27], 0
    v_mfma_f32_16x16x32_bf16 v[48:51], v[32:35], v[24:27], 0
    s_waitcnt lgkmcnt(15)
    v_cndmask_b32 v64, 0, v64, s[82:83]
    v_cndmask_b32 v65, 0, v65, s[80:81]
    v_cndmask_b32 v66, 0, v66, s[80:81]
    v_cndmask_b32 v67, 0, v67, s[80:81]
    s_nop 1
    v_mfma_f32_16x16x32_bf16 v[84:87], v[68:71], v[64:67], 0
    v_mfma_f32_16x16x32_bf16 v[88:91], v[72:75], v[64:67], 0
    s_waitcnt lgkmcnt(12)
    v_cndmask_b32 v104, 0, v104, s[82:83]
    v_cndmask_b32 v105, 0, v105, s[80:81]
    v_cndmask_b32 v106, 0, v106, s[80:81]
    v_cndmask_b32 v107, 0, v107, s[80:81]
    s_nop 1
    v_mfma_f32_16x16x32_bf16 v[124:127], v[108:111], v[104:107], 0
    v_mfma_f32_16x16x32_bf16 v[128:131], v[112:115], v[104:107], 0
    v_cndmask_b32 v44, v225, v44, s[84:85]
    v_cndmask_b32 v45, v225, v45, s[86:87]
    v_cndmask_b32 v46, v225, v46, s[88:89]
    v_cndmask_b32 v47, v225, v47, s[90:91]
    v_cndmask_b32 v48, v225, v48, s[72:73]
    v_cndmask_b32 v49, v225, v49, s[74:75]
    v_cndmask_b32 v50, v225, v50, s[76:77]
    v_cndmask_b32 v51, v225, v51, s[78:79]
    v_max3_f32 v52, v44, v45, v46
    v_max3_f32 v52, v52, v47, v48
    v_max3_f32 v52, v52, v49, v50
    v_max_f32 v52, v52, v51
    v_cndmask_b32 v84, v225, v84, s[64:65]
    v_cndmask_b32 v85, v225, v85, s[66:67]
    v_cndmask_b32 v86, v225, v86, s[68:69]
    v_cndmask_b32 v87, v225, v87, s[70:71]
    v_cndmask_b32 v88, v225, v88, s[72:73]
    v_cndmask_b32 v89, v225, v89, s[74:75]
    v_cndmask_b32 v90, v225, v90, s[76:77]
    v_cndmask_b32 v91, v225, v91, s[78:79]
    v_max3_f32 v92, v84, v85, v86
    v_max3_f32 v92, v92, v87, v88
    v_max3_f32 v92, v92, v89, v90
    v_max_f32 v92, v92, v91
    v_cndmask_b32 v124, v225, v124, s[64:65]
    v_cndmask_b32 v125, v225, v125, s[66:67]
    v_cndmask_b32 v126, v225, v126, s[68:69]
    v_cndmask_b32 v127, v225, v127, s[70:71]
    v_cndmask_b32 v128, v225, v128, s[72:73]
    v_cndmask_b32 v129, v225, v129, s[74:75]
    v_cndmask_b32 v130, v225, v130, s[76:77]
    v_cndmask_b32 v131, v225, v131, s[78:79]
    v_max3_f32 v132, v124, v125, v126
    v_max3_f32 v132, v132, v127, v128
    v_max3_f32 v132, v132, v129, v130
    v_max_f32 v132, v132, v131
    v_mov_b32 v53, v52
    v_mov_b32 v93, v92
    v_mov_b32 v133, v132
    v_permlane16_swap_b32 v52, v53
    v_permlane16_swap_b32 v92, v93
    v_permlane16_swap_b32 v132, v133
    v_max_f32 v52, v52, v53
    v_max_f32 v92, v92, v93
    v_max_f32 v132, v132, v133
    v_mov_b32 v53, v52
    v_mov_b32 v93, v92
    v_mov_b32 v133, v132
    v_permlane32_swap_b32 v52, v53
    v_permlane32_swap_b32 v92, v93
    v_permlane32_swap_b32 v132, v133
    v_max_f32 v52, v52, v53
    v_max_f32 v92, v92, v93
    v_max_f32 v132, v132, v133
    v_mul_f32 v52, s42, v52
    v_mul_f32 v92, s42, v92
    v_mul_f32 v132, s42, v132
    v_fma_f32 v44, v44, s42, -v52
    v_fma_f32 v45, v45, s42, -v52
    v_fma_f32 v46, v46, s42, -v52
    v_fma_f32 v47, v47, s42, -v52
    v_fma_f32 v48, v48, s42, -v52
    v_fma_f32 v49, v49, s42, -v52
    v_fma_f32 v50, v50, s42, -v52
    v_fma_f32 v51, v51, s42, -v52
    v_exp_f32 v44, v44
    v_exp_f32 v45, v45
    v_exp_f32 v46, v46
    v_exp_f32 v47, v47
    v_exp_f32 v48, v48
    v_exp_f32 v49, v49
    v_exp_f32 v50, v50
    v_exp_f32 v51, v51
    v_fma_f32 v84, v84, s42, -v92
    v_fma_f32 v85, v85, s42, -v92
    v_fma_f32 v86, v86, s42, -v92
    v_fma_f32 v87, v87, s42, -v92
    v_fma_f32 v88, v88, s42, -v92
    v_fma_f32 v89, v89, s42, -v92
    v_fma_f32 v90, v90, s42, -v92
    v_fma_f32 v91, v91, s42, -v92
    v_exp_f32 v84, v84
    v_exp_f32 v85, v85
    v_exp_f32 v86, v86
    v_exp_f32 v87, v87
    v_exp_f32 v88, v88
    v_exp_f32 v89, v89
    v_exp_f32 v90, v90
    v_exp_f32 v91, v91
    v_fma_f32 v124, v124, s42, -v132
    v_fma_f32 v125, v125, s42, -v132
    v_fma_f32 v126, v126, s42, -v132
    v_fma_f32 v127, v127, s42, -v132
    v_fma_f32 v128, v128, s42, -v132
    v_fma_f32 v129, v129, s42, -v132
    v_fma_f32 v130, v130, s42, -v132
    v_fma_f32 v131, v131, s42, -v132
    v_exp_f32 v124, v124
    v_exp_f32 v125, v125
    v_exp_f32 v126, v126
    v_exp_f32 v127, v127
    v_exp_f32 v128, v128
    v_exp_f32 v129, v129
    v_exp_f32 v130, v130
    v_exp_f32 v131, v131
    v_add_f32 v54, v44, v45
    v_add_f32 v55, v46, v47
    v_add_f32 v54, v54, v48
    v_add_f32 v55, v55, v49
    v_add_f32 v54, v54, v50
    v_add_f32 v55, v55, v51
    v_add_f32 v54, v54, v55
    v_add_f32 v94, v84, v85
    v_add_f32 v95, v86, v87
    v_add_f32 v94, v94, v88
    v_add_f32 v95, v95, v89
    v_add_f32 v94, v94, v90
    v_add_f32 v95, v95, v91
    v_add_f32 v94, v94, v95
    v_add_f32 v134, v124, v125
    v_add_f32 v135, v126, v127
    v_add_f32 v134, v134, v128
    v_add_f32 v135, v135, v129
    v_add_f32 v134, v134, v130
    v_add_f32 v135, v135, v131
    v_add_f32 v134, v134, v135
    v_mov_b32 v55, v54
    v_mov_b32 v95, v94
    v_mov_b32 v135, v134
    v_permlane16_swap_b32 v54, v55
    v_permlane16_swap_b32 v94, v95
    v_permlane16_swap_b32 v134, v135
    v_add_f32 v54, v54, v55
    v_add_f32 v94, v94, v95
    v_add_f32 v134, v134, v135
    v_mov_b32 v55, v54
    v_mov_b32 v95, v94
    v_mov_b32 v135, v134
    v_permlane32_swap_b32 v54, v55
    v_permlane32_swap_b32 v94, v95
    v_permlane32_swap_b32 v134, v135
    v_add_f32 v54, v54, v55
    v_add_f32 v94, v94, v95
    v_add_f32 v134, v134, v135
    v_rcp_f32 v54, v54
    v_rcp_f32 v94, v94
    v_rcp_f32 v134, v134
    s_waitcnt lgkmcnt(0)
    v_mul_f32 v44, v44, v54
    v_mul_f32 v45, v45, v54
    v_mul_f32 v46, v46, v54
    v_mul_f32 v47, v47, v54
    v_mul_f32 v48, v48, v54
    v_mul_f32 v49, v49, v54
    v_mul_f32 v50, v50, v54
    v_mul_f32 v51, v51, v54
    v_cvt_pk_bf16_f32 v24, v44, v45
    v_cvt_pk_bf16_f32 v25, v46, v47
    v_cvt_pk_bf16_f32 v26, v48, v49
    v_cvt_pk_bf16_f32 v27, v50, v51
    s_nop 1
    v_mfma_f32_16x16x32_bf16 v[56:59], v[36:39], v[24:27], 0
    v_mfma_f32_16x16x32_bf16 v[60:63], v[40:43], v[24:27], 0
    v_mul_f32 v84, v84, v94
    v_mul_f32 v85, v85, v94
    v_mul_f32 v86, v86, v94
    v_mul_f32 v87, v87, v94
    v_mul_f32 v88, v88, v94
    v_mul_f32 v89, v89, v94
    v_mul_f32 v90, v90, v94
    v_mul_f32 v91, v91, v94
    v_cvt_pk_bf16_f32 v64, v84, v85
    v_cvt_pk_bf16_f32 v65, v86, v87
    v_cvt_pk_bf16_f32 v66, v88, v89
    v_cvt_pk_bf16_f32 v67, v90, v91
    s_nop 1
    v_mfma_f32_16x16x32_bf16 v[96:99], v[76:79], v[64:67], 0
    v_mfma_f32_16x16x32_bf16 v[100:103], v[80:83], v[64:67], 0
    v_mul_f32 v124, v124, v134
    v_mul_f32 v125, v125, v134
    v_mul_f32 v126, v126, v134
    v_mul_f32 v127, v127, v134
    v_mul_f32 v128, v128, v134
    v_mul_f32 v129, v129, v134
    v_mul_f32 v130, v130, v134
    v_mul_f32 v131, v131, v134
    v_cvt_pk_bf16_f32 v104, v124, v125
    v_cvt_pk_bf16_f32 v105, v126, v127
    v_cvt_pk_bf16_f32 v106, v128, v129
    v_cvt_pk_bf16_f32 v107, v130, v131
    s_nop 1
    v_mfma_f32_16x16x32_bf16 v[136:139], v[116:119], v[104:107], 0
    v_mfma_f32_16x16x32_bf16 v[140:143], v[120:123], v[104:107], 0
    v_cvt_pk_bf16_f32 v28, v56, v57
    v_cvt_pk_bf16_f32 v29, v58, v59
    v_cvt_pk_bf16_f32 v30, v60, v61
    ds_write2_b32 v222, v28, v29 offset0:0 offset1:1
    v_cvt_pk_bf16_f32 v68, v96, v97
    v_cvt_pk_bf16_f32 v69, v98, v99
    v_cvt_pk_bf16_f32 v70, v100, v101
    ds_write2_b32 v223, v68, v69 offset0:0 offset1:1
    v_cvt_pk_bf16_f32 v108, v136, v137
    v_cvt_pk_bf16_f32 v109, v138, v139
    v_cvt_pk_bf16_f32 v110, v140, v141
    ds_write2_b32 v224, v108, v109 offset0:0 offset1:1
    s_mov_b64 exec, 0xffff
    ds_write_b32 v222, v30 offset:32
    ds_write_b32 v223, v70 offset:32
    ds_write_b32 v224, v110 offset:32
    s_mov_b64 exec, -1
    s_add_u32 s44, s26, 8392704
    s_addc_u32 s45, s27, 0
    s_and_b32 s45, s45, 0xffff
    s_mov_b32 s46, 2359296
    s_mov_b32 s47, 0x00020000
    s_waitcnt lgkmcnt(0)
    s_barrier
    ds_read_b128 v[20:23], v228
    ds_read_b128 v[24:27], v229
    s_waitcnt lgkmcnt(1)
    buffer_store_dwordx4 v[20:23], v226, s[44:47], 0 offen sc1
    s_waitcnt lgkmcnt(0)
    buffer_store_dwordx4 v[24:27], v227, s[44:47], 0 offen sc1
    s_waitcnt vmcnt(0)
    s_barrier
    s_cmp_lg_u32 s29, 0
    s_cbranch_scc1 a1f_12
    v_readfirstlane_b32 s30, v252
    s_nop 0
    s_cmp_eq_u32 s30, 0
    s_cselect_b32 s30, s28, s30
    s_lshl_b32 s36, s32, 8
    s_lshl_b32 s37, s33, 2
    s_add_u32 s36, s36, s37
    s_add_u32 s92, s26, 12587008
    s_addc_u32 s93, s27, 0
    s_and_b32 s93, s93, 0xffff
    s_mov_b32 s94, 65536
    s_mov_b32 s95, 0x00020000
    v_mov_b32 v250, s36
    v_mov_b32 v251, s30
    s_mov_b64 exec, 1
    buffer_store_dword v251, v250, s[92:95], 0 offen sc1
    s_mov_b64 exec, -1
a1f_12:
    s_cmp_lt_u32 s2, 64
    s_cbranch_scc1 L_a_b2
    s_and_b32 s90, s2, 7
    s_sub_u32 s91, s2, 64
    s_lshr_b32 s91, s91, 3
    s_sub_u32 s34, s91, 4
    s_lshr_b32 s33, s34, 1
    s_add_u32 s33, s33, 4
    s_and_b32 s34, s34, 1
    s_cmp_lt_u32 s91, 4
    s_cselect_b32 s33, s91, s33
    s_cselect_b32 s34, 0, s34
    s_cselect_b32 s42, 2, 1
    s_lshl_b32 s32, s90, 1
    s_add_u32 s32, s32, s34
    s_mov_b32 s44, s8
    s_and_b32 s45, s9, 0xffff
    s_mov_b32 s46, 663552
    s_mov_b32 s47, 0x00020000
    v_lshrrev_b32 v2, 3, v1
    v_and_b32 v3, 7, v1
    v_bfe_u32 v4, v1, 4, 1
    v_lshlrev_b32 v4, 1, v4
    v_xor_b32 v4, v4, v3
    v_mul_u32_u24 v5, 1152, v2
    v_lshl_add_u32 v5, v4, 4, v5
    s_lshl_b32 s34, s33, 7
    v_add_u32 v10, s34, v5
    v_xor_b32 v11, 64, v10
    s_mul_i32 s35, s29, 9
    s_and_b32 s36, s35, 1
    s_cmp_eq_u32 s36, 1
    s_cselect_b64 s[56:57], -1, 0
    v_cndmask_b32 v12, v10, v11, s[56:57]
    v_cndmask_b32 v13, v11, v10, s[56:57]
    s_lshl_b32 s36, s33, 3
    s_add_u32 s36, s36, s35
    s_lshl_b32 s37, s35, 10
    s_add_u32 s38, s36, 0
    s_sub_u32 s39, s38, 72
    s_cmp_ge_u32 s38, 72
    s_cselect_b32 s38, s39, s38
    s_mul_i32 s38, s38, 9216
    s_add_u32 m0, s37, 0
    s_nop 0
    buffer_load_dwordx4 v12, s[44:47], s38 offen lds
    s_add_u32 s38, s36, 1
    s_sub_u32 s39, s38, 72
    s_cmp_ge_u32 s38, 72
    s_cselect_b32 s38, s39, s38
    s_mul_i32 s38, s38, 9216
    s_add_u32 m0, s37, 1024
    s_nop 0
    buffer_load_dwordx4 v13, s[44:47], s38 offen lds
    s_add_u32 s38, s36, 2
    s_sub_u32 s39, s38, 72
    s_cmp_ge_u32 s38, 72
    s_cselect_b32 s38, s39, s38
    s_mul_i32 s38, s38, 9216
    s_add_u32 m0, s37, 2048
    s_nop 0
    buffer_load_dwordx4 v12, s[44:47], s38 offen lds
    s_add_u32 s38, s36, 3
    s_sub_u32 s39, s38, 72
    s_cmp_ge_u32 s38, 72
    s_cselect_b32 s38, s39, s38
    s_mul_i32 s38, s38, 9216
    s_add_u32 m0, s37, 3072
    s_nop 0
    buffer_load_dwordx4 v13, s[44:47], s38 offen lds
    s_add_u32 s38, s36, 4
    s_sub_u32 s39, s38, 72
    s_cmp_ge_u32 s38, 72
    s_cselect_b32 s38, s39, s38
    s_mul_i32 s38, s38, 9216
    s_add_u32 m0, s37, 4096
    s_nop 0
    buffer_load_dwordx4 v12, s[44:47], s38 offen lds
    s_add_u32 s38, s36, 5
    s_sub_u32 s39, s38, 72
    s_cmp_ge_u32 s38, 72
    s_cselect_b32 s38, s39, s38
    s_mul_i32 s38, s38, 9216
    s_add_u32 m0, s37, 5120
    s_nop 0
    buffer_load_dwordx4 v13, s[44:47], s38 offen lds
    s_add_u32 s38, s36, 6
    s_sub_u32 s39, s38, 72
    s_cmp_ge_u32 s38, 72
    s_cselect_b32 s38, s39, s38
    s_mul_i32 s38, s38, 9216
    s_add_u32 m0, s37, 6144
    s_nop 0
    buffer_load_dwordx4 v12, s[44:47], s38 offen lds
    s_add_u32 s38, s36, 7
    s_sub_u32 s39, s38, 72
    s_cmp_ge_u32 s38, 72
    s_cselect_b32 s38, s39, s38
    s_mul_i32 s38, s38, 9216
    s_add_u32 m0, s37, 7168
    s_nop 0
    buffer_load_dwordx4 v13, s[44:47], s38 offen lds
    s_add_u32 s38, s36, 8
    s_sub_u32 s39, s38, 72
    s_cmp_ge_u32 s38, 72
    s_cselect_b32 s38, s39, s38
    s_mul_i32 s38, s38, 9216
    s_add_u32 m0, s37, 8192
    s_nop 0
    buffer_load_dwordx4 v12, s[44:47], s38 offen lds
    s_add_u32 s48, s26, 8392704
    s_addc_u32 s49, s27, 0
    s_and_b32 s49, s49, 0xffff
    s_mov_b32 s50, 2359296
    s_mov_b32 s51, 0x00020000
    s_mov_b32 s52, s22
    s_and_b32 s53, s23, 0xffff
    s_mov_b32 s54, 4718592
    s_mov_b32 s55, 0x00020000
    s_lshl_b32 s38, s32, 3
    s_add_u32 s38, s38, s29
    s_mul_i32 s39, s38, 18432
    v_lshlrev_b32 v2, 4, v1
    v_add_u32 v2, s39, v2
    v_add_u32 v3, 4096, v2
    v_add_u32 v4, 8192, v2
    v_add_u32 v5, 12288, v2
    v_add_u32 v6, 16384, v2
    v_and_b32 v7, 15, v1
    v_lshrrev_b32 v8, 4, v1
    v_lshrrev_b32 v9, 2, v7
    v_lshl_add_u32 v9, v8, 3, v9
    v_lshlrev_b32 v9, 7, v9
    v_and_b32 v10, 1, v7
    v_lshl_add_u32 v9, v10, 3, v9
    v_bfe_u32 v10, v7, 3, 1
    v_and_b32 v11, 1, v8
    v_lshl_add_u32 v10, v11, 1, v10
    v_lshlrev_b32 v10, 1, v10
    v_bfe_u32 v11, v7, 1, 1
    v_add_u32 v14, 0, v11
    v_xor_b32 v14, v14, v10
    v_lshl_add_u32 v16, v14, 4, v9
    v_add_u32 v20, 36864, v16
    v_add_u32 v14, 2, v11
    v_xor_b32 v14, v14, v10
    v_lshl_add_u32 v17, v14, 4, v9
    v_add_u32 v21, 36864, v17
    v_add_u32 v14, 4, v11
    v_xor_b32 v14, v14, v10
    v_lshl_add_u32 v18, v14, 4, v9
    v_add_u32 v22, 36864, v18
    v_add_u32 v14, 6, v11
    v_xor_b32 v14, v14, v10
    v_lshl_add_u32 v19, v14, 4, v9
    v_add_u32 v23, 36864, v19
    s_mul_i32 s40, s29, 2304
    s_add_u32 s40, s40, 73728
    v_mul_u32_u24 v9, 144, v7
    v_lshl_add_u32 v9, v8, 3, v9
    v_add_u32 v9, s40, v9
    v_lshrrev_b32 v10, 3, v1
    v_and_b32 v11, 7, v1
    v_mul_u32_u24 v12, 144, v10
    v_lshl_add_u32 v12, v11, 4, v12
    v_add_u32 v12, s40, v12
    s_mul_i32 s39, s38, 36864
    s_lshl_b32 s41, s33, 7
    s_add_u32 s39, s39, s41
    v_mul_u32_u24 v13, 2304, v10
    v_lshl_add_u32 v13, v11, 4, v13
    v_add_u32 v13, s39, v13
    v_add_u32 v14, 18432, v13
    s_cmp_lg_u32 s29, 0
    s_cbranch_scc1 a2w_13
    s_lshl_b32 s39, s32, 7
    s_mul_hi_u32 s40, s39, 0x2aaaaab
    s_lshl_b32 s41, s42, 7
    s_add_u32 s39, s39, s41
    s_sub_u32 s39, s39, 1
    s_mul_hi_u32 s41, s39, 0x2aaaaab
    s_add_u32 s92, s26, 12587008
    s_addc_u32 s93, s27, 0
    s_and_b32 s93, s93, 0xffff
    s_mov_b32 s94, 65536
    s_mov_b32 s95, 0x00020000
    v_lshrrev_b32 v250, 3, v1
    v_add_u32 v250, s40, v250
    v_min_u32 v250, s41, v250
    v_lshlrev_b32 v250, 8, v250
    v_and_b32 v249, 7, v1
    v_lshl_add_u32 v250, v249, 2, v250
    s_mov_b64 exec, 0xffffffff
    s_mov_b32 s88, 1000000
poll_14:
    buffer_load_dword v251, v250, s[92:95], 0 offen sc1
    s_waitcnt vmcnt(0)
    v_cmp_ne_u32 vcc, s30, v251
    s_nop 4
    s_cbranch_vccz polld_15
    s_sleep 2
    s_sub_u32 s88, s88, 1
    s_cmp_lg_u32 s88, 0
    s_cbranch_scc1 poll_14
polld_15:
    s_mov_b64 exec, -1
a2w_13:
    s_waitcnt vmcnt(0)
    s_barrier
    s_lshl_b32 s44, s33, 1
    s_lshl_b32 s45, s44, 10
    buffer_load_dwordx4 v[24:27], v2, s[48:51], s45 offen sc1
    s_add_u32 s44, s44, 1
    s_cmp_eq_u32 s44, 18
    s_cselect_b32 s44, 0, s44
    s_lshl_b32 s45, s44, 10
    buffer_load_dwordx4 v[28:31], v2, s[48:51], s45 offen sc1
    s_add_u32 s44, s44, 1
    s_cmp_eq_u32 s44, 18
    s_cselect_b32 s44, 0, s44
    s_lshl_b32 s45, s44, 10
    buffer_load_dwordx4 v[32:35], v2, s[48:51], s45 offen sc1
    s_add_u32 s44, s44, 1
    s_cmp_eq_u32 s44, 18
    s_cselect_b32 s44, 0, s44
    s_lshl_b32 s45, s44, 10
    buffer_load_dwordx4 v[36:39], v2, s[48:51], s45 offen sc1
    s_add_u32 s44, s44, 1
    s_cmp_eq_u32 s44, 18
    s_cselect_b32 s44, 0, s44
    s_lshl_b32 s45, s44, 10
    buffer_load_dwordx4 v[40:43], v2, s[48:51], s45 offen sc1
    s_add_u32 s44, s44, 1
    s_cmp_eq_u32 s44, 18
    s_cselect_b32 s44, 0, s44
    s_lshl_b32 s45, s44, 10
    buffer_load_dwordx4 v[44:47], v2, s[48:51], s45 offen sc1
    s_add_u32 s44, s44, 1
    s_cmp_eq_u32 s44, 18
    s_cselect_b32 s44, 0, s44
    s_lshl_b32 s45, s44, 10
    buffer_load_dwordx4 v[48:51], v2, s[48:51], s45 offen sc1
    s_add_u32 s44, s44, 1
    s_cmp_eq_u32 s44, 18
    s_cselect_b32 s44, 0, s44
    s_lshl_b32 s45, s44, 10
    buffer_load_dwordx4 v[52:55], v2, s[48:51], s45 offen sc1
    s_add_u32 s44, s44, 1
    s_cmp_eq_u32 s44, 18
    s_cselect_b32 s44, 0, s44
    s_lshl_b32 s45, s44, 10
    buffer_load_dwordx4 v[56:59], v2, s[48:51], s45 offen sc1
    s_add_u32 s44, s44, 1
    s_cmp_eq_u32 s44, 18
    s_cselect_b32 s44, 0, s44
    s_lshl_b32 s45, s44, 10
    buffer_load_dwordx4 v[60:63], v2, s[48:51], s45 offen sc1
    s_add_u32 s44, s44, 1
    s_cmp_eq_u32 s44, 18
    s_cselect_b32 s44, 0, s44
    s_lshl_b32 s45, s44, 10
    buffer_load_dwordx4 v[64:67], v2, s[48:51], s45 offen sc1
    s_add_u32 s44, s44, 1
    s_cmp_eq_u32 s44, 18
    s_cselect_b32 s44, 0, s44
    s_lshl_b32 s45, s44, 10
    buffer_load_dwordx4 v[68:71], v2, s[48:51], s45 offen sc1
    s_add_u32 s44, s44, 1
    s_cmp_eq_u32 s44, 18
    s_cselect_b32 s44, 0, s44
    s_lshl_b32 s45, s44, 10
    buffer_load_dwordx4 v[72:75], v2, s[48:51], s45 offen sc1
    s_add_u32 s44, s44, 1
    s_cmp_eq_u32 s44, 18
    s_cselect_b32 s44, 0, s44
    s_lshl_b32 s45, s44, 10
    buffer_load_dwordx4 v[76:79], v2, s[48:51], s45 offen sc1
    s_add_u32 s44, s44, 1
    s_cmp_eq_u32 s44, 18
    s_cselect_b32 s44, 0, s44
    s_lshl_b32 s45, s44, 10
    buffer_load_dwordx4 v[80:83], v2, s[48:51], s45 offen sc1
    s_add_u32 s44, s44, 1
    s_cmp_eq_u32 s44, 18
    s_cselect_b32 s44, 0, s44
    s_lshl_b32 s45, s44, 10
    buffer_load_dwordx4 v[84:87], v2, s[48:51], s45 offen sc1
    s_add_u32 s44, s44, 1
    s_cmp_eq_u32 s44, 18
    s_cselect_b32 s44, 0, s44
    s_lshl_b32 s45, s44, 10
    buffer_load_dwordx4 v[88:91], v2, s[48:51], s45 offen sc1
    s_add_u32 s44, s44, 1
    s_cmp_eq_u32 s44, 18
    s_cselect_b32 s44, 0, s44
    s_lshl_b32 s45, s44, 10
    buffer_load_dwordx4 v[92:95], v2, s[48:51], s45 offen sc1
    s_add_u32 s44, s44, 1
    s_cmp_eq_u32 s44, 18
    s_cselect_b32 s44, 0, s44
    s_cmp_eq_u32 s42, 2
    s_cbranch_scc1 a2two_16
    ds_read_b64_tr_b16 v[112:113], v16 offset:0
    ds_read_b64_tr_b16 v[114:115], v16 offset:512
    ds_read_b64_tr_b16 v[116:117], v17 offset:0
    ds_read_b64_tr_b16 v[118:119], v17 offset:512
    ds_read_b64_tr_b16 v[120:121], v18 offset:0
    ds_read_b64_tr_b16 v[122:123], v18 offset:512
    ds_read_b64_tr_b16 v[124:125], v19 offset:0
    ds_read_b64_tr_b16 v[126:127], v19 offset:512
    ds_read_b64_tr_b16 v[208:209], v16 offset:4096
    ds_read_b64_tr_b16 v[210:211], v16 offset:4608
    ds_read_b64_tr_b16 v[212:213], v17 offset:4096
    ds_read_b64_tr_b16 v[214:215], v17 offset:4608
    ds_read_b64_tr_b16 v[216:217], v18 offset:4096
    ds_read_b64_tr_b16 v[218:219], v18 offset:4608
    ds_read_b64_tr_b16 v[220:221], v19 offset:4096
    ds_read_b64_tr_b16 v[222:223], v19 offset:4608
    s_waitcnt vmcnt(17) lgkmcnt(8)
    v_mfma_f32_16x16x32_bf16 v[96:99], v[112:115], v[24:27], 0
    ds_read_b64_tr_b16 v[224:225], v16 offset:8192
    ds_read_b64_tr_b16 v[226:227], v16 offset:8704
    v_mfma_f32_16x16x32_bf16 v[100:103], v[116:119], v[24:27], 0
    ds_read_b64_tr_b16 v[228:229], v17 offset:8192
    ds_read_b64_tr_b16 v[230:231], v17 offset:8704
    v_mfma_f32_16x16x32_bf16 v[104:107], v[120:123], v[24:27], 0
    ds_read_b64_tr_b16 v[232:233], v18 offset:8192
    ds_read_b64_tr_b16 v[234:235], v18 offset:8704
    v_mfma_f32_16x16x32_bf16 v[108:111], v[124:127], v[24:27], 0
    ds_read_b64_tr_b16 v[236:237], v19 offset:8192
    ds_read_b64_tr_b16 v[238:239], v19 offset:8704
    s_waitcnt vmcnt(16) lgkmcnt(8)
    v_mfma_f32_16x16x32_bf16 v[96:99], v[208:211], v[28:31], v[96:99]
    ds_read_b64_tr_b16 v[112:113], v16 offset:12288
    ds_read_b64_tr_b16 v[114:115], v16 offset:12800
    v_mfma_f32_16x16x32_bf16 v[100:103], v[212:215], v[28:31], v[100:103]
    ds_read_b64_tr_b16 v[116:117], v17 offset:12288
    ds_read_b64_tr_b16 v[118:119], v17 offset:12800
    v_mfma_f32_16x16x32_bf16 v[104:107], v[216:219], v[28:31], v[104:107]
    ds_read_b64_tr_b16 v[120:121], v18 offset:12288
    ds_read_b64_tr_b16 v[122:123], v18 offset:12800
    v_mfma_f32_16x16x32_bf16 v[108:111], v[220:223], v[28:31], v[108:111]
    ds_read_b64_tr_b16 v[124:125], v19 offset:12288
    ds_read_b64_tr_b16 v[126:127], v19 offset:12800
    s_waitcnt vmcnt(15) lgkmcnt(8)
    v_mfma_f32_16x16x32_bf16 v[96:99], v[224:227], v[32:35], v[96:99]
    ds_read_b64_tr_b16 v[208:209], v16 offset:16384
    ds_read_b64_tr_b16 v[210:211], v16 offset:16896
    v_mfma_f32_16x16x32_bf16 v[100:103], v[228:231], v[32:35], v[100:103]
    ds_read_b64_tr_b16 v[212:213], v17 offset:16384
    ds_read_b64_tr_b16 v[214:215], v17 offset:16896
    v_mfma_f32_16x16x32_bf16 v[104:107], v[232:235], v[32:35], v[104:107]
    ds_read_b64_tr_b16 v[216:217], v18 offset:16384
    ds_read_b64_tr_b16 v[218:219], v18 offset:16896
    v_mfma_f32_16x16x32_bf16 v[108:111], v[236:239], v[32:35], v[108:111]
    ds_read_b64_tr_b16 v[220:221], v19 offset:16384
    ds_read_b64_tr_b16 v[222:223], v19 offset:16896
    s_waitcnt vmcnt(14) lgkmcnt(8)
    v_mfma_f32_16x16x32_bf16 v[96:99], v[112:115], v[36:39], v[96:99]
    ds_read_b64_tr_b16 v[224:225], v16 offset:20480
    ds_read_b64_tr_b16 v[226:227], v16 offset:20992
    v_mfma_f32_16x16x32_bf16 v[100:103], v[116:119], v[36:39], v[100:103]
    ds_read_b64_tr_b16 v[228:229], v17 offset:20480
    ds_read_b64_tr_b16 v[230:231], v17 offset:20992
    v_mfma_f32_16x16x32_bf16 v[104:107], v[120:123], v[36:39], v[104:107]
    ds_read_b64_tr_b16 v[232:233], v18 offset:20480
    ds_read_b64_tr_b16 v[234:235], v18 offset:20992
    v_mfma_f32_16x16x32_bf16 v[108:111], v[124:127], v[36:39], v[108:111]
    ds_read_b64_tr_b16 v[236:237], v19 offset:20480
    ds_read_b64_tr_b16 v[238:239], v19 offset:20992
    s_waitcnt vmcnt(13) lgkmcnt(8)
    v_mfma_f32_16x16x32_bf16 v[96:99], v[208:211], v[40:43], v[96:99]
    ds_read_b64_tr_b16 v[112:113], v16 offset:24576
    ds_read_b64_tr_b16 v[114:115], v16 offset:25088
    v_mfma_f32_16x16x32_bf16 v[100:103], v[212:215], v[40:43], v[100:103]
    ds_read_b64_tr_b16 v[116:117], v17 offset:24576
    ds_read_b64_tr_b16 v[118:119], v17 offset:25088
    v_mfma_f32_16x16x32_bf16 v[104:107], v[216:219], v[40:43], v[104:107]
    ds_read_b64_tr_b16 v[120:121], v18 offset:24576
    ds_read_b64_tr_b16 v[122:123], v18 offset:25088
    v_mfma_f32_16x16x32_bf16 v[108:111], v[220:223], v[40:43], v[108:111]
    ds_read_b64_tr_b16 v[124:125], v19 offset:24576
    ds_read_b64_tr_b16 v[126:127], v19 offset:25088
    s_waitcnt vmcnt(12) lgkmcnt(8)
    v_mfma_f32_16x16x32_bf16 v[96:99], v[224:227], v[44:47], v[96:99]
    ds_read_b64_tr_b16 v[208:209], v16 offset:28672
    ds_read_b64_tr_b16 v[210:211], v16 offset:29184
    v_mfma_f32_16x16x32_bf16 v[100:103], v[228:231], v[44:47], v[100:103]
    ds_read_b64_tr_b16 v[212:213], v17 offset:28672
    ds_read_b64_tr_b16 v[214:215], v17 offset:29184
    v_mfma_f32_16x16x32_bf16 v[104:107], v[232:235], v[44:47], v[104:107]
    ds_read_b64_tr_b16 v[216:217], v18 offset:28672
    ds_read_b64_tr_b16 v[218:219], v18 offset:29184
    v_mfma_f32_16x16x32_bf16 v[108:111], v[236:239], v[44:47], v[108:111]
    ds_read_b64_tr_b16 v[220:221], v19 offset:28672
    ds_read_b64_tr_b16 v[222:223], v19 offset:29184
    s_waitcnt vmcnt(11) lgkmcnt(8)
    v_mfma_f32_16x16x32_bf16 v[96:99], v[112:115], v[48:51], v[96:99]
    ds_read_b64_tr_b16 v[224:225], v16 offset:32768
    ds_read_b64_tr_b16 v[226:227], v16 offset:33280
    v_mfma_f32_16x16x32_bf16 v[100:103], v[116:119], v[48:51], v[100:103]
    ds_read_b64_tr_b16 v[228:229], v17 offset:32768
    ds_read_b64_tr_b16 v[230:231], v17 offset:33280
    v_mfma_f32_16x16x32_bf16 v[104:107], v[120:123], v[48:51], v[104:107]
    ds_read_b64_tr_b16 v[232:233], v18 offset:32768
    ds_read_b64_tr_b16 v[234:235], v18 offset:33280
    v_mfma_f32_16x16x32_bf16 v[108:111], v[124:127], v[48:51], v[108:111]
    ds_read_b64_tr_b16 v[236:237], v19 offset:32768
    ds_read_b64_tr_b16 v[238:239], v19 offset:33280
    s_waitcnt vmcnt(10) lgkmcnt(8)
    v_mfma_f32_16x16x32_bf16 v[96:99], v[208:211], v[52:55], v[96:99]
    ds_read_b64_tr_b16 v[112:113], v20 offset:0
    ds_read_b64_tr_b16 v[114:115], v20 offset:512
    v_mfma_f32_16x16x32_bf16 v[100:103], v[212:215], v[52:55], v[100:103]
    ds_read_b64_tr_b16 v[116:117], v21 offset:0
    ds_read_b64_tr_b16 v[118:119], v21 offset:512
    v_mfma_f32_16x16x32_bf16 v[104:107], v[216:219], v[52:55], v[104:107]
    ds_read_b64_tr_b16 v[120:121], v22 offset:0
    ds_read_b64_tr_b16 v[122:123], v22 offset:512
    v_mfma_f32_16x16x32_bf16 v[108:111], v[220:223], v[52:55], v[108:111]
    ds_read_b64_tr_b16 v[124:125], v23 offset:0
    ds_read_b64_tr_b16 v[126:127], v23 offset:512
    s_waitcnt vmcnt(9) lgkmcnt(8)
    v_mfma_f32_16x16x32_bf16 v[96:99], v[224:227], v[56:59], v[96:99]
    ds_read_b64_tr_b16 v[208:209], v20 offset:4096
    ds_read_b64_tr_b16 v[210:211], v20 offset:4608
    v_mfma_f32_16x16x32_bf16 v[100:103], v[228:231], v[56:59], v[100:103]
    ds_read_b64_tr_b16 v[212:213], v21 offset:4096
    ds_read_b64_tr_b16 v[214:215], v21 offset:4608
    v_mfma_f32_16x16x32_bf16 v[104:107], v[232:235], v[56:59], v[104:107]
    ds_read_b64_tr_b16 v[216:217], v22 offset:4096
    ds_read_b64_tr_b16 v[218:219], v22 offset:4608
    v_mfma_f32_16x16x32_bf16 v[108:111], v[236:239], v[56:59], v[108:111]
    ds_read_b64_tr_b16 v[220:221], v23 offset:4096
    ds_read_b64_tr_b16 v[222:223], v23 offset:4608
    s_waitcnt vmcnt(8) lgkmcnt(8)
    v_mfma_f32_16x16x32_bf16 v[96:99], v[112:115], v[60:63], v[96:99]
    ds_read_b64_tr_b16 v[224:225], v20 offset:8192
    ds_read_b64_tr_b16 v[226:227], v20 offset:8704
    v_mfma_f32_16x16x32_bf16 v[100:103], v[116:119], v[60:63], v[100:103]
    ds_read_b64_tr_b16 v[228:229], v21 offset:8192
    ds_read_b64_tr_b16 v[230:231], v21 offset:8704
    v_mfma_f32_16x16x32_bf16 v[104:107], v[120:123], v[60:63], v[104:107]
    ds_read_b64_tr_b16 v[232:233], v22 offset:8192
    ds_read_b64_tr_b16 v[234:235], v22 offset:8704
    v_mfma_f32_16x16x32_bf16 v[108:111], v[124:127], v[60:63], v[108:111]
    ds_read_b64_tr_b16 v[236:237], v23 offset:8192
    ds_read_b64_tr_b16 v[238:239], v23 offset:8704
    s_waitcnt vmcnt(7) lgkmcnt(8)
    v_mfma_f32_16x16x32_bf16 v[96:99], v[208:211], v[64:67], v[96:99]
    ds_read_b64_tr_b16 v[112:113], v20 offset:12288
    ds_read_b64_tr_b16 v[114:115], v20 offset:12800
    v_mfma_f32_16x16x32_bf16 v[100:103], v[212:215], v[64:67], v[100:103]
    ds_read_b64_tr_b16 v[116:117], v21 offset:12288
    ds_read_b64_tr_b16 v[118:119], v21 offset:12800
    v_mfma_f32_16x16x32_bf16 v[104:107], v[216:219], v[64:67], v[104:107]
    ds_read_b64_tr_b16 v[120:121], v22 offset:12288
    ds_read_b64_tr_b16 v[122:123], v22 offset:12800
    v_mfma_f32_16x16x32_bf16 v[108:111], v[220:223], v[64:67], v[108:111]
    ds_read_b64_tr_b16 v[124:125], v23 offset:12288
    ds_read_b64_tr_b16 v[126:127], v23 offset:12800
    s_waitcnt vmcnt(6) lgkmcnt(8)
    v_mfma_f32_16x16x32_bf16 v[96:99], v[224:227], v[68:71], v[96:99]
    ds_read_b64_tr_b16 v[208:209], v20 offset:16384
    ds_read_b64_tr_b16 v[210:211], v20 offset:16896
    v_mfma_f32_16x16x32_bf16 v[100:103], v[228:231], v[68:71], v[100:103]
    ds_read_b64_tr_b16 v[212:213], v21 offset:16384
    ds_read_b64_tr_b16 v[214:215], v21 offset:16896
    v_mfma_f32_16x16x32_bf16 v[104:107], v[232:235], v[68:71], v[104:107]
    ds_read_b64_tr_b16 v[216:217], v22 offset:16384
    ds_read_b64_tr_b16 v[218:219], v22 offset:16896
    v_mfma_f32_16x16x32_bf16 v[108:111], v[236:239], v[68:71], v[108:111]
    ds_read_b64_tr_b16 v[220:221], v23 offset:16384
    ds_read_b64_tr_b16 v[222:223], v23 offset:16896
    s_waitcnt vmcnt(5) lgkmcnt(8)
    v_mfma_f32_16x16x32_bf16 v[96:99], v[112:115], v[72:75], v[96:99]
    ds_read_b64_tr_b16 v[224:225], v20 offset:20480
    ds_read_b64_tr_b16 v[226:227], v20 offset:20992
    v_mfma_f32_16x16x32_bf16 v[100:103], v[116:119], v[72:75], v[100:103]
    ds_read_b64_tr_b16 v[228:229], v21 offset:20480
    ds_read_b64_tr_b16 v[230:231], v21 offset:20992
    v_mfma_f32_16x16x32_bf16 v[104:107], v[120:123], v[72:75], v[104:107]
    ds_read_b64_tr_b16 v[232:233], v22 offset:20480
    ds_read_b64_tr_b16 v[234:235], v22 offset:20992
    v_mfma_f32_16x16x32_bf16 v[108:111], v[124:127], v[72:75], v[108:111]
    ds_read_b64_tr_b16 v[236:237], v23 offset:20480
    ds_read_b64_tr_b16 v[238:239], v23 offset:20992
    s_waitcnt vmcnt(4) lgkmcnt(8)
    v_mfma_f32_16x16x32_bf16 v[96:99], v[208:211], v[76:79], v[96:99]
    ds_read_b64_tr_b16 v[112:113], v20 offset:24576
    ds_read_b64_tr_b16 v[114:115], v20 offset:25088
    v_mfma_f32_16x16x32_bf16 v[100:103], v[212:215], v[76:79], v[100:103]
    ds_read_b64_tr_b16 v[116:117], v21 offset:24576
    ds_read_b64_tr_b16 v[118:119], v21 offset:25088
    v_mfma_f32_16x16x32_bf16 v[104:107], v[216:219], v[76:79], v[104:107]
    ds_read_b64_tr_b16 v[120:121], v22 offset:24576
    ds_read_b64_tr_b16 v[122:123], v22 offset:25088
    v_mfma_f32_16x16x32_bf16 v[108:111], v[220:223], v[76:79], v[108:111]
    ds_read_b64_tr_b16 v[124:125], v23 offset:24576
    ds_read_b64_tr_b16 v[126:127], v23 offset:25088
    s_waitcnt vmcnt(3) lgkmcnt(8)
    v_mfma_f32_16x16x32_bf16 v[96:99], v[224:227], v[80:83], v[96:99]
    ds_read_b64_tr_b16 v[208:209], v20 offset:28672
    ds_read_b64_tr_b16 v[210:211], v20 offset:29184
    v_mfma_f32_16x16x32_bf16 v[100:103], v[228:231], v[80:83], v[100:103]
    ds_read_b64_tr_b16 v[212:213], v21 offset:28672
    ds_read_b64_tr_b16 v[214:215], v21 offset:29184
    v_mfma_f32_16x16x32_bf16 v[104:107], v[232:235], v[80:83], v[104:107]
    ds_read_b64_tr_b16 v[216:217], v22 offset:28672
    ds_read_b64_tr_b16 v[218:219], v22 offset:29184
    v_mfma_f32_16x16x32_bf16 v[108:111], v[236:239], v[80:83], v[108:111]
    ds_read_b64_tr_b16 v[220:221], v23 offset:28672
    ds_read_b64_tr_b16 v[222:223], v23 offset:29184
    s_waitcnt vmcnt(2) lgkmcnt(8)
    v_mfma_f32_16x16x32_bf16 v[96:99], v[112:115], v[84:87], v[96:99]
    ds_read_b64_tr_b16 v[224:225], v20 offset:32768
    ds_read_b64_tr_b16 v[226:227], v20 offset:33280
    v_mfma_f32_16x16x32_bf16 v[100:103], v[116:119], v[84:87], v[100:103]
    ds_read_b64_tr_b16 v[228:229], v21 offset:32768
    ds_read_b64_tr_b16 v[230:231], v21 offset:33280
    v_mfma_f32_16x16x32_bf16 v[104:107], v[120:123], v[84:87], v[104:107]
    ds_read_b64_tr_b16 v[232:233], v22 offset:32768
    ds_read_b64_tr_b16 v[234:235], v22 offset:33280
    v_mfma_f32_16x16x32_bf16 v[108:111], v[124:127], v[84:87], v[108:111]
    ds_read_b64_tr_b16 v[236:237], v23 offset:32768
    ds_read_b64_tr_b16 v[238:239], v23 offset:33280
    s_waitcnt vmcnt(1) lgkmcnt(8)
    v_mfma_f32_16x16x32_bf16 v[96:99], v[208:211], v[88:91], v[96:99]
    v_mfma_f32_16x16x32_bf16 v[100:103], v[212:215], v[88:91], v[100:103]
    v_mfma_f32_16x16x32_bf16 v[104:107], v[216:219], v[88:91], v[104:107]
    v_mfma_f32_16x16x32_bf16 v[108:111], v[220:223], v[88:91], v[108:111]
    s_waitcnt vmcnt(0) lgkmcnt(0)
    v_mfma_f32_16x16x32_bf16 v[96:99], v[224:227], v[92:95], v[96:99]
    v_mfma_f32_16x16x32_bf16 v[100:103], v[228:231], v[92:95], v[100:103]
    v_mfma_f32_16x16x32_bf16 v[104:107], v[232:235], v[92:95], v[104:107]
    v_mfma_f32_16x16x32_bf16 v[108:111], v[236:239], v[92:95], v[108:111]
    s_nop 4
    v_cvt_pk_bf16_f32 v128, v96, v97
    v_cvt_pk_bf16_f32 v129, v98, v99
    ds_write_b64 v9, v[128:129] offset:0
    v_cvt_pk_bf16_f32 v130, v100, v101
    v_cvt_pk_bf16_f32 v131, v102, v103
    ds_write_b64 v9, v[130:131] offset:32
    v_cvt_pk_bf16_f32 v132, v104, v105
    v_cvt_pk_bf16_f32 v133, v106, v107
    ds_write_b64 v9, v[132:133] offset:64
    v_cvt_pk_bf16_f32 v134, v108, v109
    v_cvt_pk_bf16_f32 v135, v110, v111
    ds_write_b64 v9, v[134:135] offset:96
    s_waitcnt lgkmcnt(0)
    ds_read_b128 v[128:131], v12
    ds_read_b128 v[132:135], v12 offset:1152
    s_waitcnt lgkmcnt(1)
    buffer_store_dwordx4 v[128:131], v13, s[52:55], 0 offen sc1
    s_waitcnt lgkmcnt(0)
    buffer_store_dwordx4 v[132:135], v14, s[52:55], 0 offen sc1
    s_branch a2end_17
a2two_16:
    s_mov_b32 s43, 147456
    ds_read_b64_tr_b16 v[112:113], v16 offset:0
    ds_read_b64_tr_b16 v[114:115], v16 offset:512
    ds_read_b64_tr_b16 v[116:117], v17 offset:0
    ds_read_b64_tr_b16 v[118:119], v17 offset:512
    ds_read_b64_tr_b16 v[120:121], v18 offset:0
    ds_read_b64_tr_b16 v[122:123], v18 offset:512
    ds_read_b64_tr_b16 v[124:125], v19 offset:0
    ds_read_b64_tr_b16 v[126:127], v19 offset:512
    ds_read_b64_tr_b16 v[208:209], v16 offset:4096
    ds_read_b64_tr_b16 v[210:211], v16 offset:4608
    ds_read_b64_tr_b16 v[212:213], v17 offset:4096
    ds_read_b64_tr_b16 v[214:215], v17 offset:4608
    ds_read_b64_tr_b16 v[216:217], v18 offset:4096
    ds_read_b64_tr_b16 v[218:219], v18 offset:4608
    ds_read_b64_tr_b16 v[220:221], v19 offset:4096
    ds_read_b64_tr_b16 v[222:223], v19 offset:4608
    s_lshl_b32 s44, s33, 1
    s_waitcnt vmcnt(17) lgkmcnt(8)
    v_mfma_f32_16x16x32_bf16 v[96:99], v[112:115], v[24:27], 0
    ds_read_b64_tr_b16 v[224:225], v16 offset:8192
    ds_read_b64_tr_b16 v[226:227], v16 offset:8704
    v_mfma_f32_16x16x32_bf16 v[100:103], v[116:119], v[24:27], 0
    ds_read_b64_tr_b16 v[228:229], v17 offset:8192
    ds_read_b64_tr_b16 v[230:231], v17 offset:8704
    v_mfma_f32_16x16x32_bf16 v[104:107], v[120:123], v[24:27], 0
    ds_read_b64_tr_b16 v[232:233], v18 offset:8192
    ds_read_b64_tr_b16 v[234:235], v18 offset:8704
    v_mfma_f32_16x16x32_bf16 v[108:111], v[124:127], v[24:27], 0
    ds_read_b64_tr_b16 v[236:237], v19 offset:8192
    ds_read_b64_tr_b16 v[238:239], v19 offset:8704
    s_lshl_b32 s45, s44, 10
    s_add_u32 s45, s45, s43
    buffer_load_dwordx4 v[136:139], v2, s[48:51], s45 offen sc1
    s_add_u32 s44, s44, 1
    s_cmp_eq_u32 s44, 18
    s_cselect_b32 s44, 0, s44
    s_waitcnt vmcnt(17) lgkmcnt(8)
    v_mfma_f32_16x16x32_bf16 v[96:99], v[208:211], v[28:31], v[96:99]
    ds_read_b64_tr_b16 v[112:113], v16 offset:12288
    ds_read_b64_tr_b16 v[114:115], v16 offset:12800
    v_mfma_f32_16x16x32_bf16 v[100:103], v[212:215], v[28:31], v[100:103]
    ds_read_b64_tr_b16 v[116:117], v17 offset:12288
    ds_read_b64_tr_b16 v[118:119], v17 offset:12800
    v_mfma_f32_16x16x32_bf16 v[104:107], v[216:219], v[28:31], v[104:107]
    ds_read_b64_tr_b16 v[120:121], v18 offset:12288
    ds_read_b64_tr_b16 v[122:123], v18 offset:12800
    v_mfma_f32_16x16x32_bf16 v[108:111], v[220:223], v[28:31], v[108:111]
    ds_read_b64_tr_b16 v[124:125], v19 offset:12288
    ds_read_b64_tr_b16 v[126:127], v19 offset:12800
    s_lshl_b32 s45, s44, 10
    s_add_u32 s45, s45, s43
    buffer_load_dwordx4 v[140:143], v2, s[48:51], s45 offen sc1
    s_add_u32 s44, s44, 1
    s_cmp_eq_u32 s44, 18
    s_cselect_b32 s44, 0, s44
    s_waitcnt vmcnt(17) lgkmcnt(8)
    v_mfma_f32_16x16x32_bf16 v[96:99], v[224:227], v[32:35], v[96:99]
    ds_read_b64_tr_b16 v[208:209], v16 offset:16384
    ds_read_b64_tr_b16 v[210:211], v16 offset:16896
    v_mfma_f32_16x16x32_bf16 v[100:103], v[228:231], v[32:35], v[100:103]
    ds_read_b64_tr_b16 v[212:213], v17 offset:16384
    ds_read_b64_tr_b16 v[214:215], v17 offset:16896
    v_mfma_f32_16x16x32_bf16 v[104:107], v[232:235], v[32:35], v[104:107]
    ds_read_b64_tr_b16 v[216:217], v18 offset:16384
    ds_read_b64_tr_b16 v[218:219], v18 offset:16896
    v_mfma_f32_16x16x32_bf16 v[108:111], v[236:239], v[32:35], v[108:111]
    ds_read_b64_tr_b16 v[220:221], v19 offset:16384
    ds_read_b64_tr_b16 v[222:223], v19 offset:16896
    s_lshl_b32 s45, s44, 10
    s_add_u32 s45, s45, s43
    buffer_load_dwordx4 v[144:147], v2, s[48:51], s45 offen sc1
    s_add_u32 s44, s44, 1
    s_cmp_eq_u32 s44, 18
    s_cselect_b32 s44, 0, s44
    s_waitcnt vmcnt(17) lgkmcnt(8)
    v_mfma_f32_16x16x32_bf16 v[96:99], v[112:115], v[36:39], v[96:99]
    ds_read_b64_tr_b16 v[224:225], v16 offset:20480
    ds_read_b64_tr_b16 v[226:227], v16 offset:20992
    v_mfma_f32_16x16x32_bf16 v[100:103], v[116:119], v[36:39], v[100:103]
    ds_read_b64_tr_b16 v[228:229], v17 offset:20480
    ds_read_b64_tr_b16 v[230:231], v17 offset:20992
    v_mfma_f32_16x16x32_bf16 v[104:107], v[120:123], v[36:39], v[104:107]
    ds_read_b64_tr_b16 v[232:233], v18 offset:20480
    ds_read_b64_tr_b16 v[234:235], v18 offset:20992
    v_mfma_f32_16x16x32_bf16 v[108:111], v[124:127], v[36:39], v[108:111]
    ds_read_b64_tr_b16 v[236:237], v19 offset:20480
    ds_read_b64_tr_b16 v[238:239], v19 offset:20992
    s_lshl_b32 s45, s44, 10
    s_add_u32 s45, s45, s43
    buffer_load_dwordx4 v[148:151], v2, s[48:51], s45 offen sc1
    s_add_u32 s44, s44, 1
    s_cmp_eq_u32 s44, 18
    s_cselect_b32 s44, 0, s44
    s_waitcnt vmcnt(17) lgkmcnt(8)
    v_mfma_f32_16x16x32_bf16 v[96:99], v[208:211], v[40:43], v[96:99]
    ds_read_b64_tr_b16 v[112:113], v16 offset:24576
    ds_read_b64_tr_b16 v[114:115], v16 offset:25088
    v_mfma_f32_16x16x32_bf16 v[100:103], v[212:215], v[40:43], v[100:103]
    ds_read_b64_tr_b16 v[116:117], v17 offset:24576
    ds_read_b64_tr_b16 v[118:119], v17 offset:25088
    v_mfma_f32_16x16x32_bf16 v[104:107], v[216:219], v[40:43], v[104:107]
    ds_read_b64_tr_b16 v[120:121], v18 offset:24576
    ds_read_b64_tr_b16 v[122:123], v18 offset:25088
    v_mfma_f32_16x16x32_bf16 v[108:111], v[220:223], v[40:43], v[108:111]
    ds_read_b64_tr_b16 v[124:125], v19 offset:24576
    ds_read_b64_tr_b16 v[126:127], v19 offset:25088
    s_lshl_b32 s45, s44, 10
    s_add_u32 s45, s45, s43
    buffer_load_dwordx4 v[152:155], v2, s[48:51], s45 offen sc1
    s_add_u32 s44, s44, 1
    s_cmp_eq_u32 s44, 18
    s_cselect_b32 s44, 0, s44
    s_waitcnt vmcnt(17) lgkmcnt(8)
    v_mfma_f32_16x16x32_bf16 v[96:99], v[224:227], v[44:47], v[96:99]
    ds_read_b64_tr_b16 v[208:209], v16 offset:28672
    ds_read_b64_tr_b16 v[210:211], v16 offset:29184
    v_mfma_f32_16x16x32_bf16 v[100:103], v[228:231], v[44:47], v[100:103]
    ds_read_b64_tr_b16 v[212:213], v17 offset:28672
    ds_read_b64_tr_b16 v[214:215], v17 offset:29184
    v_mfma_f32_16x16x32_bf16 v[104:107], v[232:235], v[44:47], v[104:107]
    ds_read_b64_tr_b16 v[216:217], v18 offset:28672
    ds_read_b64_tr_b16 v[218:219], v18 offset:29184
    v_mfma_f32_16x16x32_bf16 v[108:111], v[236:239], v[44:47], v[108:111]
    ds_read_b64_tr_b16 v[220:221], v19 offset:28672
    ds_read_b64_tr_b16 v[222:223], v19 offset:29184
    s_lshl_b32 s45, s44, 10
    s_add_u32 s45, s45, s43
    buffer_load_dwordx4 v[156:159], v2, s[48:51], s45 offen sc1
    s_add_u32 s44, s44, 1
    s_cmp_eq_u32 s44, 18
    s_cselect_b32 s44, 0, s44
    s_waitcnt vmcnt(17) lgkmcnt(8)
    v_mfma_f32_16x16x32_bf16 v[96:99], v[112:115], v[48:51], v[96:99]
    ds_read_b64_tr_b16 v[224:225], v16 offset:32768
    ds_read_b64_tr_b16 v[226:227], v16 offset:33280
    v_mfma_f32_16x16x32_bf16 v[100:103], v[116:119], v[48:51], v[100:103]
    ds_read_b64_tr_b16 v[228:229], v17 offset:32768
    ds_read_b64_tr_b16 v[230:231], v17 offset:33280
    v_mfma_f32_16x16x32_bf16 v[104:107], v[120:123], v[48:51], v[104:107]
    ds_read_b64_tr_b16 v[232:233], v18 offset:32768
    ds_read_b64_tr_b16 v[234:235], v18 offset:33280
    v_mfma_f32_16x16x32_bf16 v[108:111], v[124:127], v[48:51], v[108:111]
    ds_read_b64_tr_b16 v[236:237], v19 offset:32768
    ds_read_b64_tr_b16 v[238:239], v19 offset:33280
    s_lshl_b32 s45, s44, 10
    s_add_u32 s45, s45, s43
    buffer_load_dwordx4 v[160:163], v2, s[48:51], s45 offen sc1
    s_add_u32 s44, s44, 1
    s_cmp_eq_u32 s44, 18
    s_cselect_b32 s44, 0, s44
    s_waitcnt vmcnt(17) lgkmcnt(8)
    v_mfma_f32_16x16x32_bf16 v[96:99], v[208:211], v[52:55], v[96:99]
    ds_read_b64_tr_b16 v[112:113], v20 offset:0
    ds_read_b64_tr_b16 v[114:115], v20 offset:512
    v_mfma_f32_16x16x32_bf16 v[100:103], v[212:215], v[52:55], v[100:103]
    ds_read_b64_tr_b16 v[116:117], v21 offset:0
    ds_read_b64_tr_b16 v[118:119], v21 offset:512
    v_mfma_f32_16x16x32_bf16 v[104:107], v[216:219], v[52:55], v[104:107]
    ds_read_b64_tr_b16 v[120:121], v22 offset:0
    ds_read_b64_tr_b16 v[122:123], v22 offset:512
    v_mfma_f32_16x16x32_bf16 v[108:111], v[220:223], v[52:55], v[108:111]
    ds_read_b64_tr_b16 v[124:125], v23 offset:0
    ds_read_b64_tr_b16 v[126:127], v23 offset:512
    s_lshl_b32 s45, s44, 10
    s_add_u32 s45, s45, s43
    buffer_load_dwordx4 v[164:167], v2, s[48:51], s45 offen sc1
    s_add_u32 s44, s44, 1
    s_cmp_eq_u32 s44, 18
    s_cselect_b32 s44, 0, s44
    s_waitcnt vmcnt(17) lgkmcnt(8)
    v_mfma_f32_16x16x32_bf16 v[96:99], v[224:227], v[56:59], v[96:99]
    ds_read_b64_tr_b16 v[208:209], v20 offset:4096
    ds_read_b64_tr_b16 v[210:211], v20 offset:4608
    v_mfma_f32_16x16x32_bf16 v[100:103], v[228:231], v[56:59], v[100:103]
    ds_read_b64_tr_b16 v[212:213], v21 offset:4096
    ds_read_b64_tr_b16 v[214:215], v21 offset:4608
    v_mfma_f32_16x16x32_bf16 v[104:107], v[232:235], v[56:59], v[104:107]
    ds_read_b64_tr_b16 v[216:217], v22 offset:4096
    ds_read_b64_tr_b16 v[218:219], v22 offset:4608
    v_mfma_f32_16x16x32_bf16 v[108:111], v[236:239], v[56:59], v[108:111]
    ds_read_b64_tr_b16 v[220:221], v23 offset:4096
    ds_read_b64_tr_b16 v[222:223], v23 offset:4608
    s_lshl_b32 s45, s44, 10
    s_add_u32 s45, s45, s43
    buffer_load_dwordx4 v[168:171], v2, s[48:51], s45 offen sc1
    s_add_u32 s44, s44, 1
    s_cmp_eq_u32 s44, 18
    s_cselect_b32 s44, 0, s44
    s_waitcnt vmcnt(17) lgkmcnt(8)
    v_mfma_f32_16x16x32_bf16 v[96:99], v[112:115], v[60:63], v[96:99]
    ds_read_b64_tr_b16 v[224:225], v20 offset:8192
    ds_read_b64_tr_b16 v[226:227], v20 offset:8704
    v_mfma_f32_16x16x32_bf16 v[100:103], v[116:119], v[60:63], v[100:103]
    ds_read_b64_tr_b16 v[228:229], v21 offset:8192
    ds_read_b64_tr_b16 v[230:231], v21 offset:8704
    v_mfma_f32_16x16x32_bf16 v[104:107], v[120:123], v[60:63], v[104:107]
    ds_read_b64_tr_b16 v[232:233], v22 offset:8192
    ds_read_b64_tr_b16 v[234:235], v22 offset:8704
    v_mfma_f32_16x16x32_bf16 v[108:111], v[124:127], v[60:63], v[108:111]
    ds_read_b64_tr_b16 v[236:237], v23 offset:8192
    ds_read_b64_tr_b16 v[238:239], v23 offset:8704
    s_lshl_b32 s45, s44, 10
    s_add_u32 s45, s45, s43
    buffer_load_dwordx4 v[172:175], v2, s[48:51], s45 offen sc1
    s_add_u32 s44, s44, 1
    s_cmp_eq_u32 s44, 18
    s_cselect_b32 s44, 0, s44
    s_waitcnt vmcnt(17) lgkmcnt(8)
    v_mfma_f32_16x16x32_bf16 v[96:99], v[208:211], v[64:67], v[96:99]
    ds_read_b64_tr_b16 v[112:113], v20 offset:12288
    ds_read_b64_tr_b16 v[114:115], v20 offset:12800
    v_mfma_f32_16x16x32_bf16 v[100:103], v[212:215], v[64:67], v[100:103]
    ds_read_b64_tr_b16 v[116:117], v21 offset:12288
    ds_read_b64_tr_b16 v[118:119], v21 offset:12800
    v_mfma_f32_16x16x32_bf16 v[104:107], v[216:219], v[64:67], v[104:107]
    ds_read_b64_tr_b16 v[120:121], v22 offset:12288
    ds_read_b64_tr_b16 v[122:123], v22 offset:12800
    v_mfma_f32_16x16x32_bf16 v[108:111], v[220:223], v[64:67], v[108:111]
    ds_read_b64_tr_b16 v[124:125], v23 offset:12288
    ds_read_b64_tr_b16 v[126:127], v23 offset:12800
    s_lshl_b32 s45, s44, 10
    s_add_u32 s45, s45, s43
    buffer_load_dwordx4 v[176:179], v2, s[48:51], s45 offen sc1
    s_add_u32 s44, s44, 1
    s_cmp_eq_u32 s44, 18
    s_cselect_b32 s44, 0, s44
    s_waitcnt vmcnt(17) lgkmcnt(8)
    v_mfma_f32_16x16x32_bf16 v[96:99], v[224:227], v[68:71], v[96:99]
    ds_read_b64_tr_b16 v[208:209], v20 offset:16384
    ds_read_b64_tr_b16 v[210:211], v20 offset:16896
    v_mfma_f32_16x16x32_bf16 v[100:103], v[228:231], v[68:71], v[100:103]
    ds_read_b64_tr_b16 v[212:213], v21 offset:16384
    ds_read_b64_tr_b16 v[214:215], v21 offset:16896
    v_mfma_f32_16x16x32_bf16 v[104:107], v[232:235], v[68:71], v[104:107]
    ds_read_b64_tr_b16 v[216:217], v22 offset:16384
    ds_read_b64_tr_b16 v[218:219], v22 offset:16896
    v_mfma_f32_16x16x32_bf16 v[108:111], v[236:239], v[68:71], v[108:111]
    ds_read_b64_tr_b16 v[220:221], v23 offset:16384
    ds_read_b64_tr_b16 v[222:223], v23 offset:16896
    s_lshl_b32 s45, s44, 10
    s_add_u32 s45, s45, s43
    buffer_load_dwordx4 v[180:183], v2, s[48:51], s45 offen sc1
    s_add_u32 s44, s44, 1
    s_cmp_eq_u32 s44, 18
    s_cselect_b32 s44, 0, s44
    s_waitcnt vmcnt(17) lgkmcnt(8)
    v_mfma_f32_16x16x32_bf16 v[96:99], v[112:115], v[72:75], v[96:99]
    ds_read_b64_tr_b16 v[224:225], v20 offset:20480
    ds_read_b64_tr_b16 v[226:227], v20 offset:20992
    v_mfma_f32_16x16x32_bf16 v[100:103], v[116:119], v[72:75], v[100:103]
    ds_read_b64_tr_b16 v[228:229], v21 offset:20480
    ds_read_b64_tr_b16 v[230:231], v21 offset:20992
    v_mfma_f32_16x16x32_bf16 v[104:107], v[120:123], v[72:75], v[104:107]
    ds_read_b64_tr_b16 v[232:233], v22 offset:20480
    ds_read_b64_tr_b16 v[234:235], v22 offset:20992
    v_mfma_f32_16x16x32_bf16 v[108:111], v[124:127], v[72:75], v[108:111]
    ds_read_b64_tr_b16 v[236:237], v23 offset:20480
    ds_read_b64_tr_b16 v[238:239], v23 offset:20992
    s_lshl_b32 s45, s44, 10
    s_add_u32 s45, s45, s43
    buffer_load_dwordx4 v[184:187], v2, s[48:51], s45 offen sc1
    s_add_u32 s44, s44, 1
    s_cmp_eq_u32 s44, 18
    s_cselect_b32 s44, 0, s44
    s_waitcnt vmcnt(17) lgkmcnt(8)
    v_mfma_f32_16x16x32_bf16 v[96:99], v[208:211], v[76:79], v[96:99]
    ds_read_b64_tr_b16 v[112:113], v20 offset:24576
    ds_read_b64_tr_b16 v[114:115], v20 offset:25088
    v_mfma_f32_16x16x32_bf16 v[100:103], v[212:215], v[76:79], v[100:103]
    ds_read_b64_tr_b16 v[116:117], v21 offset:24576
    ds_read_b64_tr_b16 v[118:119], v21 offset:25088
    v_mfma_f32_16x16x32_bf16 v[104:107], v[216:219], v[76:79], v[104:107]
    ds_read_b64_tr_b16 v[120:121], v22 offset:24576
    ds_read_b64_tr_b16 v[122:123], v22 offset:25088
    v_mfma_f32_16x16x32_bf16 v[108:111], v[220:223], v[76:79], v[108:111]
    ds_read_b64_tr_b16 v[124:125], v23 offset:24576
    ds_read_b64_tr_b16 v[126:127], v23 offset:25088
    s_lshl_b32 s45, s44, 10
    s_add_u32 s45, s45, s43
    buffer_load_dwordx4 v[188:191], v2, s[48:51], s45 offen sc1
    s_add_u32 s44, s44, 1
    s_cmp_eq_u32 s44, 18
    s_cselect_b32 s44, 0, s44
    s_waitcnt vmcnt(17) lgkmcnt(8)
    v_mfma_f32_16x16x32_bf16 v[96:99], v[224:227], v[80:83], v[96:99]
    ds_read_b64_tr_b16 v[208:209], v20 offset:28672
    ds_read_b64_tr_b16 v[210:211], v20 offset:29184
    v_mfma_f32_16x16x32_bf16 v[100:103], v[228:231], v[80:83], v[100:103]
    ds_read_b64_tr_b16 v[212:213], v21 offset:28672
    ds_read_b64_tr_b16 v[214:215], v21 offset:29184
    v_mfma_f32_16x16x32_bf16 v[104:107], v[232:235], v[80:83], v[104:107]
    ds_read_b64_tr_b16 v[216:217], v22 offset:28672
    ds_read_b64_tr_b16 v[218:219], v22 offset:29184
    v_mfma_f32_16x16x32_bf16 v[108:111], v[236:239], v[80:83], v[108:111]
    ds_read_b64_tr_b16 v[220:221], v23 offset:28672
    ds_read_b64_tr_b16 v[222:223], v23 offset:29184
    s_lshl_b32 s45, s44, 10
    s_add_u32 s45, s45, s43
    buffer_load_dwordx4 v[192:195], v2, s[48:51], s45 offen sc1
    s_add_u32 s44, s44, 1
    s_cmp_eq_u32 s44, 18
    s_cselect_b32 s44, 0, s44
    s_waitcnt vmcnt(17) lgkmcnt(8)
    v_mfma_f32_16x16x32_bf16 v[96:99], v[112:115], v[84:87], v[96:99]
    ds_read_b64_tr_b16 v[224:225], v20 offset:32768
    ds_read_b64_tr_b16 v[226:227], v20 offset:33280
    v_mfma_f32_16x16x32_bf16 v[100:103], v[116:119], v[84:87], v[100:103]
    ds_read_b64_tr_b16 v[228:229], v21 offset:32768
    ds_read_b64_tr_b16 v[230:231], v21 offset:33280
    v_mfma_f32_16x16x32_bf16 v[104:107], v[120:123], v[84:87], v[104:107]
    ds_read_b64_tr_b16 v[232:233], v22 offset:32768
    ds_read_b64_tr_b16 v[234:235], v22 offset:33280
    v_mfma_f32_16x16x32_bf16 v[108:111], v[124:127], v[84:87], v[108:111]
    ds_read_b64_tr_b16 v[236:237], v23 offset:32768
    ds_read_b64_tr_b16 v[238:239], v23 offset:33280
    s_lshl_b32 s45, s44, 10
    s_add_u32 s45, s45, s43
    buffer_load_dwordx4 v[196:199], v2, s[48:51], s45 offen sc1
    s_add_u32 s44, s44, 1
    s_cmp_eq_u32 s44, 18
    s_cselect_b32 s44, 0, s44
    s_waitcnt vmcnt(17) lgkmcnt(8)
    v_mfma_f32_16x16x32_bf16 v[96:99], v[208:211], v[88:91], v[96:99]
    v_mfma_f32_16x16x32_bf16 v[100:103], v[212:215], v[88:91], v[100:103]
    v_mfma_f32_16x16x32_bf16 v[104:107], v[216:219], v[88:91], v[104:107]
    v_mfma_f32_16x16x32_bf16 v[108:111], v[220:223], v[88:91], v[108:111]
    s_lshl_b32 s45, s44, 10
    s_add_u32 s45, s45, s43
    buffer_load_dwordx4 v[200:203], v2, s[48:51], s45 offen sc1
    s_add_u32 s44, s44, 1
    s_cmp_eq_u32 s44, 18
    s_cselect_b32 s44, 0, s44
    s_waitcnt vmcnt(17) lgkmcnt(0)
    v_mfma_f32_16x16x32_bf16 v[96:99], v[224:227], v[92:95], v[96:99]
    v_mfma_f32_16x16x32_bf16 v[100:103], v[228:231], v[92:95], v[100:103]
    v_mfma_f32_16x16x32_bf16 v[104:107], v[232:235], v[92:95], v[104:107]
    v_mfma_f32_16x16x32_bf16 v[108:111], v[236:239], v[92:95], v[108:111]
    s_lshl_b32 s45, s44, 10
    s_add_u32 s45, s45, s43
    buffer_load_dwordx4 v[204:207], v2, s[48:51], s45 offen sc1
    s_add_u32 s44, s44, 1
    s_cmp_eq_u32 s44, 18
    s_cselect_b32 s44, 0, s44
    v_cvt_pk_bf16_f32 v128, v96, v97
    v_cvt_pk_bf16_f32 v129, v98, v99
    ds_write_b64 v9, v[128:129] offset:0
    v_cvt_pk_bf16_f32 v130, v100, v101
    v_cvt_pk_bf16_f32 v131, v102, v103
    ds_write_b64 v9, v[130:131] offset:32
    v_cvt_pk_bf16_f32 v132, v104, v105
    v_cvt_pk_bf16_f32 v133, v106, v107
    ds_write_b64 v9, v[132:133] offset:64
    v_cvt_pk_bf16_f32 v134, v108, v109
    v_cvt_pk_bf16_f32 v135, v110, v111
    ds_write_b64 v9, v[134:135] offset:96
    s_waitcnt lgkmcnt(0)
    ds_read_b128 v[128:131], v12
    ds_read_b128 v[132:135], v12 offset:1152
    s_waitcnt lgkmcnt(1)
    buffer_store_dwordx4 v[128:131], v13, s[52:55], 0 offen sc1
    s_waitcnt lgkmcnt(0)
    buffer_store_dwordx4 v[132:135], v14, s[52:55], 0 offen sc1
    s_mov_b32 s43, 294912
    ds_read_b64_tr_b16 v[112:113], v16 offset:0
    ds_read_b64_tr_b16 v[114:115], v16 offset:512
    ds_read_b64_tr_b16 v[116:117], v17 offset:0
    ds_read_b64_tr_b16 v[118:119], v17 offset:512
    ds_read_b64_tr_b16 v[120:121], v18 offset:0
    ds_read_b64_tr_b16 v[122:123], v18 offset:512
    ds_read_b64_tr_b16 v[124:125], v19 offset:0
    ds_read_b64_tr_b16 v[126:127], v19 offset:512
    ds_read_b64_tr_b16 v[208:209], v16 offset:4096
    ds_read_b64_tr_b16 v[210:211], v16 offset:4608
    ds_read_b64_tr_b16 v[212:213], v17 offset:4096
    ds_read_b64_tr_b16 v[214:215], v17 offset:4608
    ds_read_b64_tr_b16 v[216:217], v18 offset:4096
    ds_read_b64_tr_b16 v[218:219], v18 offset:4608
    ds_read_b64_tr_b16 v[220:221], v19 offset:4096
    ds_read_b64_tr_b16 v[222:223], v19 offset:4608
    s_waitcnt vmcnt(19) lgkmcnt(8)
    v_mfma_f32_16x16x32_bf16 v[96:99], v[112:115], v[136:139], 0
    ds_read_b64_tr_b16 v[224:225], v16 offset:8192
    ds_read_b64_tr_b16 v[226:227], v16 offset:8704
    v_mfma_f32_16x16x32_bf16 v[100:103], v[116:119], v[136:139], 0
    ds_read_b64_tr_b16 v[228:229], v17 offset:8192
    ds_read_b64_tr_b16 v[230:231], v17 offset:8704
    v_mfma_f32_16x16x32_bf16 v[104:107], v[120:123], v[136:139], 0
    ds_read_b64_tr_b16 v[232:233], v18 offset:8192
    ds_read_b64_tr_b16 v[234:235], v18 offset:8704
    v_mfma_f32_16x16x32_bf16 v[108:111], v[124:127], v[136:139], 0
    ds_read_b64_tr_b16 v[236:237], v19 offset:8192
    ds_read_b64_tr_b16 v[238:239], v19 offset:8704
    s_waitcnt vmcnt(18) lgkmcnt(8)
    v_mfma_f32_16x16x32_bf16 v[96:99], v[208:211], v[140:143], v[96:99]
    ds_read_b64_tr_b16 v[112:113], v16 offset:12288
    ds_read_b64_tr_b16 v[114:115], v16 offset:12800
    v_mfma_f32_16x16x32_bf16 v[100:103], v[212:215], v[140:143], v[100:103]
    ds_read_b64_tr_b16 v[116:117], v17 offset:12288
    ds_read_b64_tr_b16 v[118:119], v17 offset:12800
    v_mfma_f32_16x16x32_bf16 v[104:107], v[216:219], v[140:143], v[104:107]
    ds_read_b64_tr_b16 v[120:121], v18 offset:12288
    ds_read_b64_tr_b16 v[122:123], v18 offset:12800
    v_mfma_f32_16x16x32_bf16 v[108:111], v[220:223], v[140:143], v[108:111]
    ds_read_b64_tr_b16 v[124:125], v19 offset:12288
    ds_read_b64_tr_b16 v[126:127], v19 offset:12800
    s_waitcnt vmcnt(17) lgkmcnt(8)
    v_mfma_f32_16x16x32_bf16 v[96:99], v[224:227], v[144:147], v[96:99]
    ds_read_b64_tr_b16 v[208:209], v16 offset:16384
    ds_read_b64_tr_b16 v[210:211], v16 offset:16896
    v_mfma_f32_16x16x32_bf16 v[100:103], v[228:231], v[144:147], v[100:103]
    ds_read_b64_tr_b16 v[212:213], v17 offset:16384
    ds_read_b64_tr_b16 v[214:215], v17 offset:16896
    v_mfma_f32_16x16x32_bf16 v[104:107], v[232:235], v[144:147], v[104:107]
    ds_read_b64_tr_b16 v[216:217], v18 offset:16384
    ds_read_b64_tr_b16 v[218:219], v18 offset:16896
    v_mfma_f32_16x16x32_bf16 v[108:111], v[236:239], v[144:147], v[108:111]
    ds_read_b64_tr_b16 v[220:221], v19 offset:16384
    ds_read_b64_tr_b16 v[222:223], v19 offset:16896
    s_waitcnt vmcnt(16) lgkmcnt(8)
    v_mfma_f32_16x16x32_bf16 v[96:99], v[112:115], v[148:151], v[96:99]
    ds_read_b64_tr_b16 v[224:225], v16 offset:20480
    ds_read_b64_tr_b16 v[226:227], v16 offset:20992
    v_mfma_f32_16x16x32_bf16 v[100:103], v[116:119], v[148:151], v[100:103]
    ds_read_b64_tr_b16 v[228:229], v17 offset:20480
    ds_read_b64_tr_b16 v[230:231], v17 offset:20992
    v_mfma_f32_16x16x32_bf16 v[104:107], v[120:123], v[148:151], v[104:107]
    ds_read_b64_tr_b16 v[232:233], v18 offset:20480
    ds_read_b64_tr_b16 v[234:235], v18 offset:20992
    v_mfma_f32_16x16x32_bf16 v[108:111], v[124:127], v[148:151], v[108:111]
    ds_read_b64_tr_b16 v[236:237], v19 offset:20480
    ds_read_b64_tr_b16 v[238:239], v19 offset:20992
    s_waitcnt vmcnt(15) lgkmcnt(8)
    v_mfma_f32_16x16x32_bf16 v[96:99], v[208:211], v[152:155], v[96:99]
    ds_read_b64_tr_b16 v[112:113], v16 offset:24576
    ds_read_b64_tr_b16 v[114:115], v16 offset:25088
    v_mfma_f32_16x16x32_bf16 v[100:103], v[212:215], v[152:155], v[100:103]
    ds_read_b64_tr_b16 v[116:117], v17 offset:24576
    ds_read_b64_tr_b16 v[118:119], v17 offset:25088
    v_mfma_f32_16x16x32_bf16 v[104:107], v[216:219], v[152:155], v[104:107]
    ds_read_b64_tr_b16 v[120:121], v18 offset:24576
    ds_read_b64_tr_b16 v[122:123], v18 offset:25088
    v_mfma_f32_16x16x32_bf16 v[108:111], v[220:223], v[152:155], v[108:111]
    ds_read_b64_tr_b16 v[124:125], v19 offset:24576
    ds_read_b64_tr_b16 v[126:127], v19 offset:25088
    s_waitcnt vmcnt(14) lgkmcnt(8)
    v_mfma_f32_16x16x32_bf16 v[96:99], v[224:227], v[156:159], v[96:99]
    ds_read_b64_tr_b16 v[208:209], v16 offset:28672
    ds_read_b64_tr_b16 v[210:211], v16 offset:29184
    v_mfma_f32_16x16x32_bf16 v[100:103], v[228:231], v[156:159], v[100:103]
    ds_read_b64_tr_b16 v[212:213], v17 offset:28672
    ds_read_b64_tr_b16 v[214:215], v17 offset:29184
    v_mfma_f32_16x16x32_bf16 v[104:107], v[232:235], v[156:159], v[104:107]
    ds_read_b64_tr_b16 v[216:217], v18 offset:28672
    ds_read_b64_tr_b16 v[218:219], v18 offset:29184
    v_mfma_f32_16x16x32_bf16 v[108:111], v[236:239], v[156:159], v[108:111]
    ds_read_b64_tr_b16 v[220:221], v19 offset:28672
    ds_read_b64_tr_b16 v[222:223], v19 offset:29184
    s_waitcnt vmcnt(13) lgkmcnt(8)
    v_mfma_f32_16x16x32_bf16 v[96:99], v[112:115], v[160:163], v[96:99]
    ds_read_b64_tr_b16 v[224:225], v16 offset:32768
    ds_read_b64_tr_b16 v[226:227], v16 offset:33280
    v_mfma_f32_16x16x32_bf16 v[100:103], v[116:119], v[160:163], v[100:103]
    ds_read_b64_tr_b16 v[228:229], v17 offset:32768
    ds_read_b64_tr_b16 v[230:231], v17 offset:33280
    v_mfma_f32_16x16x32_bf16 v[104:107], v[120:123], v[160:163], v[104:107]
    ds_read_b64_tr_b16 v[232:233], v18 offset:32768
    ds_read_b64_tr_b16 v[234:235], v18 offset:33280
    v_mfma_f32_16x16x32_bf16 v[108:111], v[124:127], v[160:163], v[108:111]
    ds_read_b64_tr_b16 v[236:237], v19 offset:32768
    ds_read_b64_tr_b16 v[238:239], v19 offset:33280
    s_waitcnt vmcnt(12) lgkmcnt(8)
    v_mfma_f32_16x16x32_bf16 v[96:99], v[208:211], v[164:167], v[96:99]
    ds_read_b64_tr_b16 v[112:113], v20 offset:0
    ds_read_b64_tr_b16 v[114:115], v20 offset:512
    v_mfma_f32_16x16x32_bf16 v[100:103], v[212:215], v[164:167], v[100:103]
    ds_read_b64_tr_b16 v[116:117], v21 offset:0
    ds_read_b64_tr_b16 v[118:119], v21 offset:512
    v_mfma_f32_16x16x32_bf16 v[104:107], v[216:219], v[164:167], v[104:107]
    ds_read_b64_tr_b16 v[120:121], v22 offset:0
    ds_read_b64_tr_b16 v[122:123], v22 offset:512
    v_mfma_f32_16x16x32_bf16 v[108:111], v[220:223], v[164:167], v[108:111]
    ds_read_b64_tr_b16 v[124:125], v23 offset:0
    ds_read_b64_tr_b16 v[126:127], v23 offset:512
    s_waitcnt vmcnt(11) lgkmcnt(8)
    v_mfma_f32_16x16x32_bf16 v[96:99], v[224:227], v[168:171], v[96:99]
    ds_read_b64_tr_b16 v[208:209], v20 offset:4096
    ds_read_b64_tr_b16 v[210:211], v20 offset:4608
    v_mfma_f32_16x16x32_bf16 v[100:103], v[228:231], v[168:171], v[100:103]
    ds_read_b64_tr_b16 v[212:213], v21 offset:4096
    ds_read_b64_tr_b16 v[214:215], v21 offset:4608
    v_mfma_f32_16x16x32_bf16 v[104:107], v[232:235], v[168:171], v[104:107]
    ds_read_b64_tr_b16 v[216:217], v22 offset:4096
    ds_read_b64_tr_b16 v[218:219], v22 offset:4608
    v_mfma_f32_16x16x32_bf16 v[108:111], v[236:239], v[168:171], v[108:111]
    ds_read_b64_tr_b16 v[220:221], v23 offset:4096
    ds_read_b64_tr_b16 v[222:223], v23 offset:4608
    s_waitcnt vmcnt(10) lgkmcnt(8)
    v_mfma_f32_16x16x32_bf16 v[96:99], v[112:115], v[172:175], v[96:99]
    ds_read_b64_tr_b16 v[224:225], v20 offset:8192
    ds_read_b64_tr_b16 v[226:227], v20 offset:8704
    v_mfma_f32_16x16x32_bf16 v[100:103], v[116:119], v[172:175], v[100:103]
    ds_read_b64_tr_b16 v[228:229], v21 offset:8192
    ds_read_b64_tr_b16 v[230:231], v21 offset:8704
    v_mfma_f32_16x16x32_bf16 v[104:107], v[120:123], v[172:175], v[104:107]
    ds_read_b64_tr_b16 v[232:233], v22 offset:8192
    ds_read_b64_tr_b16 v[234:235], v22 offset:8704
    v_mfma_f32_16x16x32_bf16 v[108:111], v[124:127], v[172:175], v[108:111]
    ds_read_b64_tr_b16 v[236:237], v23 offset:8192
    ds_read_b64_tr_b16 v[238:239], v23 offset:8704
    s_waitcnt vmcnt(9) lgkmcnt(8)
    v_mfma_f32_16x16x32_bf16 v[96:99], v[208:211], v[176:179], v[96:99]
    ds_read_b64_tr_b16 v[112:113], v20 offset:12288
    ds_read_b64_tr_b16 v[114:115], v20 offset:12800
    v_mfma_f32_16x16x32_bf16 v[100:103], v[212:215], v[176:179], v[100:103]
    ds_read_b64_tr_b16 v[116:117], v21 offset:12288
    ds_read_b64_tr_b16 v[118:119], v21 offset:12800
    v_mfma_f32_16x16x32_bf16 v[104:107], v[216:219], v[176:179], v[104:107]
    ds_read_b64_tr_b16 v[120:121], v22 offset:12288
    ds_read_b64_tr_b16 v[122:123], v22 offset:12800
    v_mfma_f32_16x16x32_bf16 v[108:111], v[220:223], v[176:179], v[108:111]
    ds_read_b64_tr_b16 v[124:125], v23 offset:12288
    ds_read_b64_tr_b16 v[126:127], v23 offset:12800
    s_waitcnt vmcnt(8) lgkmcnt(8)
    v_mfma_f32_16x16x32_bf16 v[96:99], v[224:227], v[180:183], v[96:99]
    ds_read_b64_tr_b16 v[208:209], v20 offset:16384
    ds_read_b64_tr_b16 v[210:211], v20 offset:16896
    v_mfma_f32_16x16x32_bf16 v[100:103], v[228:231], v[180:183], v[100:103]
    ds_read_b64_tr_b16 v[212:213], v21 offset:16384
    ds_read_b64_tr_b16 v[214:215], v21 offset:16896
    v_mfma_f32_16x16x32_bf16 v[104:107], v[232:235], v[180:183], v[104:107]
    ds_read_b64_tr_b16 v[216:217], v22 offset:16384
    ds_read_b64_tr_b16 v[218:219], v22 offset:16896
    v_mfma_f32_16x16x32_bf16 v[108:111], v[236:239], v[180:183], v[108:111]
    ds_read_b64_tr_b16 v[220:221], v23 offset:16384
    ds_read_b64_tr_b16 v[222:223], v23 offset:16896
    s_waitcnt vmcnt(7) lgkmcnt(8)
    v_mfma_f32_16x16x32_bf16 v[96:99], v[112:115], v[184:187], v[96:99]
    ds_read_b64_tr_b16 v[224:225], v20 offset:20480
    ds_read_b64_tr_b16 v[226:227], v20 offset:20992
    v_mfma_f32_16x16x32_bf16 v[100:103], v[116:119], v[184:187], v[100:103]
    ds_read_b64_tr_b16 v[228:229], v21 offset:20480
    ds_read_b64_tr_b16 v[230:231], v21 offset:20992
    v_mfma_f32_16x16x32_bf16 v[104:107], v[120:123], v[184:187], v[104:107]
    ds_read_b64_tr_b16 v[232:233], v22 offset:20480
    ds_read_b64_tr_b16 v[234:235], v22 offset:20992
    v_mfma_f32_16x16x32_bf16 v[108:111], v[124:127], v[184:187], v[108:111]
    ds_read_b64_tr_b16 v[236:237], v23 offset:20480
    ds_read_b64_tr_b16 v[238:239], v23 offset:20992
    s_waitcnt vmcnt(6) lgkmcnt(8)
    v_mfma_f32_16x16x32_bf16 v[96:99], v[208:211], v[188:191], v[96:99]
    ds_read_b64_tr_b16 v[112:113], v20 offset:24576
    ds_read_b64_tr_b16 v[114:115], v20 offset:25088
    v_mfma_f32_16x16x32_bf16 v[100:103], v[212:215], v[188:191], v[100:103]
    ds_read_b64_tr_b16 v[116:117], v21 offset:24576
    ds_read_b64_tr_b16 v[118:119], v21 offset:25088
    v_mfma_f32_16x16x32_bf16 v[104:107], v[216:219], v[188:191], v[104:107]
    ds_read_b64_tr_b16 v[120:121], v22 offset:24576
    ds_read_b64_tr_b16 v[122:123], v22 offset:25088
    v_mfma_f32_16x16x32_bf16 v[108:111], v[220:223], v[188:191], v[108:111]
    ds_read_b64_tr_b16 v[124:125], v23 offset:24576
    ds_read_b64_tr_b16 v[126:127], v23 offset:25088
    s_waitcnt vmcnt(5) lgkmcnt(8)
    v_mfma_f32_16x16x32_bf16 v[96:99], v[224:227], v[192:195], v[96:99]
    ds_read_b64_tr_b16 v[208:209], v20 offset:28672
    ds_read_b64_tr_b16 v[210:211], v20 offset:29184
    v_mfma_f32_16x16x32_bf16 v[100:103], v[228:231], v[192:195], v[100:103]
    ds_read_b64_tr_b16 v[212:213], v21 offset:28672
    ds_read_b64_tr_b16 v[214:215], v21 offset:29184
    v_mfma_f32_16x16x32_bf16 v[104:107], v[232:235], v[192:195], v[104:107]
    ds_read_b64_tr_b16 v[216:217], v22 offset:28672
    ds_read_b64_tr_b16 v[218:219], v22 offset:29184
    v_mfma_f32_16x16x32_bf16 v[108:111], v[236:239], v[192:195], v[108:111]
    ds_read_b64_tr_b16 v[220:221], v23 offset:28672
    ds_read_b64_tr_b16 v[222:223], v23 offset:29184
    s_waitcnt vmcnt(4) lgkmcnt(8)
    v_mfma_f32_16x16x32_bf16 v[96:99], v[112:115], v[196:199], v[96:99]
    ds_read_b64_tr_b16 v[224:225], v20 offset:32768
    ds_read_b64_tr_b16 v[226:227], v20 offset:33280
    v_mfma_f32_16x16x32_bf16 v[100:103], v[116:119], v[196:199], v[100:103]
    ds_read_b64_tr_b16 v[228:229], v21 offset:32768
    ds_read_b64_tr_b16 v[230:231], v21 offset:33280
    v_mfma_f32_16x16x32_bf16 v[104:107], v[120:123], v[196:199], v[104:107]
    ds_read_b64_tr_b16 v[232:233], v22 offset:32768
    ds_read_b64_tr_b16 v[234:235], v22 offset:33280
    v_mfma_f32_16x16x32_bf16 v[108:111], v[124:127], v[196:199], v[108:111]
    ds_read_b64_tr_b16 v[236:237], v23 offset:32768
    ds_read_b64_tr_b16 v[238:239], v23 offset:33280
    s_waitcnt vmcnt(3) lgkmcnt(8)
    v_mfma_f32_16x16x32_bf16 v[96:99], v[208:211], v[200:203], v[96:99]
    v_mfma_f32_16x16x32_bf16 v[100:103], v[212:215], v[200:203], v[100:103]
    v_mfma_f32_16x16x32_bf16 v[104:107], v[216:219], v[200:203], v[104:107]
    v_mfma_f32_16x16x32_bf16 v[108:111], v[220:223], v[200:203], v[108:111]
    s_waitcnt vmcnt(2) lgkmcnt(0)
    v_mfma_f32_16x16x32_bf16 v[96:99], v[224:227], v[204:207], v[96:99]
    v_mfma_f32_16x16x32_bf16 v[100:103], v[228:231], v[204:207], v[100:103]
    v_mfma_f32_16x16x32_bf16 v[104:107], v[232:235], v[204:207], v[104:107]
    v_mfma_f32_16x16x32_bf16 v[108:111], v[236:239], v[204:207], v[108:111]
    s_nop 4
    v_cvt_pk_bf16_f32 v128, v96, v97
    v_cvt_pk_bf16_f32 v129, v98, v99
    ds_write_b64 v9, v[128:129] offset:0
    v_cvt_pk_bf16_f32 v130, v100, v101
    v_cvt_pk_bf16_f32 v131, v102, v103
    ds_write_b64 v9, v[130:131] offset:32
    v_cvt_pk_bf16_f32 v132, v104, v105
    v_cvt_pk_bf16_f32 v133, v106, v107
    ds_write_b64 v9, v[132:133] offset:64
    v_cvt_pk_bf16_f32 v134, v108, v109
    v_cvt_pk_bf16_f32 v135, v110, v111
    ds_write_b64 v9, v[134:135] offset:96
    s_waitcnt lgkmcnt(0)
    ds_read_b128 v[128:131], v12
    ds_read_b128 v[132:135], v12 offset:1152
    s_waitcnt lgkmcnt(1)
    buffer_store_dwordx4 v[128:131], v13, s[52:55], s43 offen sc1
    s_waitcnt lgkmcnt(0)
    buffer_store_dwordx4 v[132:135], v14, s[52:55], s43 offen sc1
a2end_17:
    s_branch L_fin
L_a_b2:
    s_and_b32 s89, s2, 7
    s_lshr_b32 s91, s2, 3
    s_add_u32 s91, s91, 10
    s_lshl_b32 s90, s89, 4
    s_add_u32 s90, s90, s91
    s_lshl_b32 s40, s89, 1
    s_add_u32 s40, s40, s91
    s_add_u32 s40, s40, 112
    s_cmp_lt_u32 s91, 16
    s_cselect_b32 s90, s90, s40
    s_cmp_lg_u32 s29, 0
    s_cbranch_scc1 nz_18
    s_mov_b32 s92, s24
    s_and_b32 s93, s25, 0xffff
    s_mov_b32 s94, 256
    s_mov_b32 s95, 0x00020000
    v_mov_b32 v254, s28
    v_mov_b32 v255, 0
    v_mov_b32 v251, 128
    s_mov_b64 exec, 1
    buffer_atomic_cmpswap v[254:255], v251, s[92:95], 0 offen sc0 sc1
    s_mov_b64 exec, -1
nz_18:
    s_and_b32 s32, s29, 3
    s_lshr_b32 s33, s29, 2
    s_lshl_b32 s34, s90, 2
    s_add_u32 s34, s34, s32
    s_lshl_b32 s35, s34, 12
    s_mul_i32 s36, s32, 21248
    s_add_u32 s44, s18, s35
    s_addc_u32 s45, s19, 0
    s_and_b32 s45, s45, 0xffff
    s_mov_b32 s46, 4096
    s_mov_b32 s47, 0x00020000
    s_lshl_b32 s37, s34, 1
    s_and_b32 s38, s37, 0xfffffffc
    s_load_dword s39, s[20:21], s38
    s_waitcnt vmcnt(0)
    v_add_u32 v197, s36, v196
    v_alignbit_b32 v112, v174, v170, 16
    v_alignbit_b32 v113, v175, v171, 16
    v_alignbit_b32 v114, v176, v172, 16
    v_alignbit_b32 v115, v177, v173, 16
    v_alignbit_b32 v116, v178, v174, 16
    v_alignbit_b32 v117, v179, v175, 16
    v_alignbit_b32 v118, v180, v176, 16
    v_alignbit_b32 v119, v181, v177, 16
    ds_write_b128 v197, v[170:173] offset:32
    ds_write_b128 v197, v[112:115] offset:4192
    ds_write_b128 v197, v[174:177] offset:8352
    ds_write_b128 v197, v[116:119] offset:12512
    v_alignbit_b32 v112, v186, v182, 16
    v_alignbit_b32 v113, v187, v183, 16
    v_alignbit_b32 v114, v188, v184, 16
    v_alignbit_b32 v115, v189, v185, 16
    v_alignbit_b32 v116, v190, v186, 16
    v_alignbit_b32 v117, v191, v187, 16
    v_alignbit_b32 v118, v192, v188, 16
    v_alignbit_b32 v119, v193, v189, 16
    ds_write_b128 v197, v[182:185] offset:1056
    ds_write_b128 v197, v[112:115] offset:5216
    ds_write_b128 v197, v[186:189] offset:9376
    ds_write_b128 v197, v[116:119] offset:13536
    v_lshlrev_b32 v120, 16, v194
    v_alignbit_b32 v121, v195, v194, 16
    v_mov_b64 v[122:123], 0
    v_mov_b64 v[124:125], 0
    v_mov_b64 v[126:127], 0
    v_mov_b64 v[128:129], 0
    v_cmp_eq_u32 s[60:61], 1, v1
    v_cmp_eq_u32 s[62:63], 2, v1
    v_cmp_eq_u32 s[64:65], 3, v1
    v_cndmask_b32 v129, v129, v120, s[60:61]
    v_cndmask_b32 v129, v129, v194, s[62:63]
    v_cndmask_b32 v129, v129, v121, s[64:65]
    v_cndmask_b32 v128, v128, v120, s[64:65]
    v_mul_u32_u24 v198, 4160, v1
    v_add_u32 v198, s36, v198
    s_mov_b64 exec, 0xf
    ds_write_b128 v198, v[122:125]
    ds_write_b128 v198, v[126:129] offset:16
    s_mov_b64 exec, 0xffffffff
    v_lshlrev_b32 v198, 4, v1
    v_add_u32 v198, s36, v198
    ds_write_b128 v198, v[122:125] offset:20736
    s_mov_b64 exec, -1
    s_add_u32 s48, s26, s35
    s_addc_u32 s49, s27, 0
    s_add_u32 s48, s48, 4096
    s_addc_u32 s49, s49, 0
    s_and_b32 s49, s49, 0xffff
    s_mov_b32 s50, 4096
    s_mov_b32 s51, 0x00020000
    s_mov_b32 s52, s10
    s_and_b32 s53, s11, 0xffff
    s_mov_b32 s54, 2359296
    s_mov_b32 s55, 0x00020000
    s_mov_b32 s56, s22
    s_and_b32 s57, s23, 0xffff
    s_mov_b32 s58, 4718592
    s_mov_b32 s59, 0x00020000
    v_and_b32 v3, 15, v1
    v_lshrrev_b32 v4, 4, v1
    v_lshlrev_b32 v5, 4, v1
    s_lshl_b32 s40, s33, 11
    v_add_u32 v5, s40, v5
    v_add_u32 v10, s36, v5
    v_lshlrev_b32 v9, 5, v3
    v_lshl_add_u32 v9, v4, 3, v9
    s_lshl_b32 s41, s29, 8
    v_add_u32 v8, s41, v1
    s_movk_i32 s42, 1152
    v_mul_lo_u32 v8, v8, s42
    s_lshl_b32 s43, s90, 3
    v_add_u32 v8, s43, v8
    v_add_u32 v12, 1, v3
    v_and_b32 v13, 3, v12
    v_lshrrev_b32 v12, 2, v12
    v_mul_u32_u24 v13, 4160, v13
    v_lshl_add_u32 v13, v4, 4, v13
    v_lshl_add_u32 v13, v12, 3, v13
    s_lshl_b32 s41, s33, 8
    s_add_u32 s41, s41, s36
    v_add_u32 v13, s41, v13
    v_lshlrev_b32 v14, 4, v4
    v_lshlrev_b32 v15, 5, v3
    v_sub_u32 v14, v14, v15
    v_add_u32 v14, 17120, v14
    v_add_u32 v14, s41, v14
    s_cmp_lg_u32 s29, 0
    s_cbranch_scc1 b2w_19
    s_waitcnt vmcnt(0)
    v_readfirstlane_b32 s31, v254
    s_nop 0
    s_cmp_eq_u32 s31, 0
    s_cselect_b32 s31, s28, s31
    s_lshr_b32 s41, s90, 4
    s_lshl_b32 s41, s41, 8
    s_add_u32 s92, s26, 12652544
    s_addc_u32 s93, s27, 0
    s_and_b32 s93, s93, 0xffff
    s_mov_b32 s94, 65536
    s_mov_b32 s95, 0x00020000
    v_and_b32 v250, 7, v1
    v_lshlrev_b32 v250, 2, v250
    v_add_u32 v250, s41, v250
    s_mov_b64 exec, 0xff
    s_mov_b32 s88, 1000000
poll_20:
    buffer_load_dword v251, v250, s[92:95], 0 offen sc1
    s_waitcnt vmcnt(0)
    v_cmp_ne_u32 vcc, s31, v251
    s_nop 4
    s_cbranch_vccz polld_21
    s_sleep 2
    s_sub_u32 s88, s88, 1
    s_cmp_lg_u32 s88, 0
    s_cbranch_scc1 poll_20
polld_21:
    s_mov_b64 exec, -1
b2w_19:
    s_barrier
    buffer_load_dwordx4 v[68:71], v5, s[48:51], 0 offen offset:0 sc1
    buffer_load_dwordx4 v[72:75], v5, s[48:51], 0 offen offset:1024 sc1
    s_lshl_b32 s41, s29, 12
    v_lshlrev_b32 v6, 4, v1
    v_add_u32 v6, 84992, v6
    v_add_u32 v7, s41, v6
    s_xor_b32 s42, s29, 4
    s_lshl_b32 s42, s42, 12
    v_add_u32 v6, s42, v6
    v_sub_u32 v11, 17144, v9
    s_lshl_b32 s41, s33, 11
    s_sub_u32 s42, s36, s41
    v_add_u32 v11, s42, v11
    s_mul_i32 s42, s32, 4160
    s_add_u32 s42, s42, s41
    v_add_u32 v9, s42, v9
    s_waitcnt vmcnt(0)
    ds_write_b128 v10, v[68:71] offset:16640
    ds_write_b128 v10, v[72:75] offset:17664
    s_mov_b32 s60, 0
    s_mov_b32 s61, 73728
    s_mov_b32 s62, 147456
    s_mov_b32 s63, 221184
    s_waitcnt lgkmcnt(0)
    s_barrier
    ds_read_b64 v[104:105], v13 offset:0
    ds_read_b64 v[106:107], v13 offset:8
    ds_read_b128 v[136:139], v14 offset:3584
    ds_read_b128 v[140:143], v14 offset:3072
    ds_read_b128 v[144:147], v14 offset:2560
    ds_read_b128 v[148:151], v14 offset:2048
    ds_read_b128 v[152:155], v14 offset:1536
    ds_read_b128 v[156:159], v14 offset:1024
    ds_read_b128 v[160:163], v14 offset:512
    ds_read_b128 v[164:167], v14 offset:0
    ds_read_b64 v[108:109], v13 offset:512
    ds_read_b64 v[110:111], v13 offset:520
    ds_read_b64 v[112:113], v13 offset:1024
    ds_read_b64 v[114:115], v13 offset:1032
    ds_read_b64 v[116:117], v13 offset:1536
    ds_read_b64 v[118:119], v13 offset:1544
    ds_read_b64 v[120:121], v13 offset:2048
    ds_read_b64 v[122:123], v13 offset:2056
    ds_read_b64 v[124:125], v13 offset:2560
    ds_read_b64 v[126:127], v13 offset:2568
    ds_read_b64 v[128:129], v13 offset:3072
    ds_read_b64 v[130:131], v13 offset:3080
    ds_read_b64 v[132:133], v13 offset:3584
    ds_read_b64 v[134:135], v13 offset:3592
    s_waitcnt lgkmcnt(0)
    buffer_load_dwordx2 v[84:85], v8, s[52:55], s60 offen
    v_mfma_f32_16x16x32_bf16 v[208:211], v[104:107], v[136:139], 0
    ds_read_b64 v[16:17], v13 offset:64
    v_mfma_f32_16x16x32_bf16 v[212:215], v[104:107], v[140:143], 0
    ds_read_b64 v[18:19], v13 offset:72
    v_mfma_f32_16x16x32_bf16 v[216:219], v[104:107], v[144:147], 0
    ds_read_b128 v[48:51], v14 offset:3648
    v_mfma_f32_16x16x32_bf16 v[220:223], v[104:107], v[148:151], 0
    ds_read_b128 v[52:55], v14 offset:3136
    v_mfma_f32_16x16x32_bf16 v[224:227], v[104:107], v[152:155], 0
    ds_read_b128 v[56:59], v14 offset:2624
    v_mfma_f32_16x16x32_bf16 v[228:231], v[104:107], v[156:159], 0
    ds_read_b128 v[60:63], v14 offset:2112
    v_mfma_f32_16x16x32_bf16 v[232:235], v[104:107], v[160:163], 0
    ds_read_b128 v[64:67], v14 offset:1600
    v_mfma_f32_16x16x32_bf16 v[236:239], v[104:107], v[164:167], 0
    ds_read_b128 v[68:71], v14 offset:1088
    v_mfma_f32_16x16x32_bf16 v[212:215], v[108:111], v[136:139], v[212:215]
    ds_read_b128 v[72:75], v14 offset:576
    v_mfma_f32_16x16x32_bf16 v[216:219], v[108:111], v[140:143], v[216:219]
    ds_read_b128 v[76:79], v14 offset:64
    v_mfma_f32_16x16x32_bf16 v[220:223], v[108:111], v[144:147], v[220:223]
    ds_read_b64 v[20:21], v13 offset:576
    v_mfma_f32_16x16x32_bf16 v[224:227], v[108:111], v[148:151], v[224:227]
    ds_read_b64 v[22:23], v13 offset:584
    v_mfma_f32_16x16x32_bf16 v[228:231], v[108:111], v[152:155], v[228:231]
    ds_read_b64 v[24:25], v13 offset:1088
    v_mfma_f32_16x16x32_bf16 v[232:235], v[108:111], v[156:159], v[232:235]
    ds_read_b64 v[26:27], v13 offset:1096
    v_mfma_f32_16x16x32_bf16 v[236:239], v[108:111], v[160:163], v[236:239]
    ds_read_b64 v[28:29], v13 offset:1600
    v_mfma_f32_16x16x32_bf16 v[216:219], v[112:115], v[136:139], v[216:219]
    ds_read_b64 v[30:31], v13 offset:1608
    v_mfma_f32_16x16x32_bf16 v[220:223], v[112:115], v[140:143], v[220:223]
    ds_read_b64 v[32:33], v13 offset:2112
    v_mfma_f32_16x16x32_bf16 v[224:227], v[112:115], v[144:147], v[224:227]
    ds_read_b64 v[34:35], v13 offset:2120
    v_mfma_f32_16x16x32_bf16 v[228:231], v[112:115], v[148:151], v[228:231]
    ds_read_b64 v[36:37], v13 offset:2624
    v_mfma_f32_16x16x32_bf16 v[232:235], v[112:115], v[152:155], v[232:235]
    ds_read_b64 v[38:39], v13 offset:2632
    v_mfma_f32_16x16x32_bf16 v[236:239], v[112:115], v[156:159], v[236:239]
    ds_read_b64 v[40:41], v13 offset:3136
    v_mfma_f32_16x16x32_bf16 v[220:223], v[116:119], v[136:139], v[220:223]
    ds_read_b64 v[42:43], v13 offset:3144
    v_mfma_f32_16x16x32_bf16 v[224:227], v[116:119], v[140:143], v[224:227]
    ds_read_b64 v[44:45], v13 offset:3648
    v_mfma_f32_16x16x32_bf16 v[228:231], v[116:119], v[144:147], v[228:231]
    ds_read_b64 v[46:47], v13 offset:3656
    v_mfma_f32_16x16x32_bf16 v[232:235], v[116:119], v[148:151], v[232:235]
    v_mfma_f32_16x16x32_bf16 v[236:239], v[116:119], v[152:155], v[236:239]
    v_mfma_f32_16x16x32_bf16 v[224:227], v[120:123], v[136:139], v[224:227]
    v_mfma_f32_16x16x32_bf16 v[228:231], v[120:123], v[140:143], v[228:231]
    v_mfma_f32_16x16x32_bf16 v[232:235], v[120:123], v[144:147], v[232:235]
    v_mfma_f32_16x16x32_bf16 v[236:239], v[120:123], v[148:151], v[236:239]
    v_mfma_f32_16x16x32_bf16 v[228:231], v[124:127], v[136:139], v[228:231]
    v_mfma_f32_16x16x32_bf16 v[232:235], v[124:127], v[140:143], v[232:235]
    v_mfma_f32_16x16x32_bf16 v[236:239], v[124:127], v[144:147], v[236:239]
    v_mfma_f32_16x16x32_bf16 v[232:235], v[128:131], v[136:139], v[232:235]
    v_mfma_f32_16x16x32_bf16 v[236:239], v[128:131], v[140:143], v[236:239]
    v_mfma_f32_16x16x32_bf16 v[236:239], v[132:135], v[136:139], v[236:239]
    s_waitcnt lgkmcnt(0)
    buffer_load_dwordx2 v[86:87], v8, s[52:55], s61 offen
    v_mfma_f32_16x16x32_bf16 v[208:211], v[16:19], v[48:51], v[208:211]
    ds_read_b64 v[104:105], v13 offset:128
    v_mfma_f32_16x16x32_bf16 v[212:215], v[16:19], v[52:55], v[212:215]
    ds_read_b64 v[106:107], v13 offset:136
    v_mfma_f32_16x16x32_bf16 v[216:219], v[16:19], v[56:59], v[216:219]
    ds_read_b128 v[136:139], v14 offset:3712
    v_mfma_f32_16x16x32_bf16 v[220:223], v[16:19], v[60:63], v[220:223]
    ds_read_b128 v[140:143], v14 offset:3200
    v_mfma_f32_16x16x32_bf16 v[224:227], v[16:19], v[64:67], v[224:227]
    ds_read_b128 v[144:147], v14 offset:2688
    v_mfma_f32_16x16x32_bf16 v[228:231], v[16:19], v[68:71], v[228:231]
    ds_read_b128 v[148:151], v14 offset:2176
    v_mfma_f32_16x16x32_bf16 v[232:235], v[16:19], v[72:75], v[232:235]
    ds_read_b128 v[152:155], v14 offset:1664
    v_mfma_f32_16x16x32_bf16 v[236:239], v[16:19], v[76:79], v[236:239]
    ds_read_b128 v[156:159], v14 offset:1152
    v_mfma_f32_16x16x32_bf16 v[212:215], v[20:23], v[48:51], v[212:215]
    ds_read_b128 v[160:163], v14 offset:640
    v_mfma_f32_16x16x32_bf16 v[216:219], v[20:23], v[52:55], v[216:219]
    ds_read_b128 v[164:167], v14 offset:128
    v_mfma_f32_16x16x32_bf16 v[220:223], v[20:23], v[56:59], v[220:223]
    ds_read_b64 v[108:109], v13 offset:640
    v_mfma_f32_16x16x32_bf16 v[224:227], v[20:23], v[60:63], v[224:227]
    ds_read_b64 v[110:111], v13 offset:648
    v_mfma_f32_16x16x32_bf16 v[228:231], v[20:23], v[64:67], v[228:231]
    ds_read_b64 v[112:113], v13 offset:1152
    v_mfma_f32_16x16x32_bf16 v[232:235], v[20:23], v[68:71], v[232:235]
    ds_read_b64 v[114:115], v13 offset:1160
    v_mfma_f32_16x16x32_bf16 v[236:239], v[20:23], v[72:75], v[236:239]
    ds_read_b64 v[116:117], v13 offset:1664
    v_mfma_f32_16x16x32_bf16 v[216:219], v[24:27], v[48:51], v[216:219]
    ds_read_b64 v[118:119], v13 offset:1672
    v_mfma_f32_16x16x32_bf16 v[220:223], v[24:27], v[52:55], v[220:223]
    ds_read_b64 v[120:121], v13 offset:2176
    v_mfma_f32_16x16x32_bf16 v[224:227], v[24:27], v[56:59], v[224:227]
    ds_read_b64 v[122:123], v13 offset:2184
    v_mfma_f32_16x16x32_bf16 v[228:231], v[24:27], v[60:63], v[228:231]
    ds_read_b64 v[124:125], v13 offset:2688
    v_mfma_f32_16x16x32_bf16 v[232:235], v[24:27], v[64:67], v[232:235]
    ds_read_b64 v[126:127], v13 offset:2696
    v_mfma_f32_16x16x32_bf16 v[236:239], v[24:27], v[68:71], v[236:239]
    ds_read_b64 v[128:129], v13 offset:3200
    v_mfma_f32_16x16x32_bf16 v[220:223], v[28:31], v[48:51], v[220:223]
    ds_read_b64 v[130:131], v13 offset:3208
    v_mfma_f32_16x16x32_bf16 v[224:227], v[28:31], v[52:55], v[224:227]
    ds_read_b64 v[132:133], v13 offset:3712
    v_mfma_f32_16x16x32_bf16 v[228:231], v[28:31], v[56:59], v[228:231]
    ds_read_b64 v[134:135], v13 offset:3720
    v_mfma_f32_16x16x32_bf16 v[232:235], v[28:31], v[60:63], v[232:235]
    v_mfma_f32_16x16x32_bf16 v[236:239], v[28:31], v[64:67], v[236:239]
    v_mfma_f32_16x16x32_bf16 v[224:227], v[32:35], v[48:51], v[224:227]
    v_mfma_f32_16x16x32_bf16 v[228:231], v[32:35], v[52:55], v[228:231]
    v_mfma_f32_16x16x32_bf16 v[232:235], v[32:35], v[56:59], v[232:235]
    v_mfma_f32_16x16x32_bf16 v[236:239], v[32:35], v[60:63], v[236:239]
    v_mfma_f32_16x16x32_bf16 v[228:231], v[36:39], v[48:51], v[228:231]
    v_mfma_f32_16x16x32_bf16 v[232:235], v[36:39], v[52:55], v[232:235]
    v_mfma_f32_16x16x32_bf16 v[236:239], v[36:39], v[56:59], v[236:239]
    v_mfma_f32_16x16x32_bf16 v[232:235], v[40:43], v[48:51], v[232:235]
    v_mfma_f32_16x16x32_bf16 v[236:239], v[40:43], v[52:55], v[236:239]
    v_mfma_f32_16x16x32_bf16 v[236:239], v[44:47], v[48:51], v[236:239]
    s_waitcnt lgkmcnt(0)
    buffer_load_dwordx2 v[88:89], v8, s[52:55], s62 offen
    v_mfma_f32_16x16x32_bf16 v[208:211], v[104:107], v[136:139], v[208:211]
    ds_read_b64 v[16:17], v13 offset:192
    v_mfma_f32_16x16x32_bf16 v[212:215], v[104:107], v[140:143], v[212:215]
    ds_read_b64 v[18:19], v13 offset:200
    v_mfma_f32_16x16x32_bf16 v[216:219], v[104:107], v[144:147], v[216:219]
    ds_read_b128 v[48:51], v14 offset:3776
    v_mfma_f32_16x16x32_bf16 v[220:223], v[104:107], v[148:151], v[220:223]
    ds_read_b128 v[52:55], v14 offset:3264
    v_mfma_f32_16x16x32_bf16 v[224:227], v[104:107], v[152:155], v[224:227]
    ds_read_b128 v[56:59], v14 offset:2752
    v_mfma_f32_16x16x32_bf16 v[228:231], v[104:107], v[156:159], v[228:231]
    ds_read_b128 v[60:63], v14 offset:2240
    v_mfma_f32_16x16x32_bf16 v[232:235], v[104:107], v[160:163], v[232:235]
    ds_read_b128 v[64:67], v14 offset:1728
    v_mfma_f32_16x16x32_bf16 v[236:239], v[104:107], v[164:167], v[236:239]
    ds_read_b128 v[68:71], v14 offset:1216
    v_mfma_f32_16x16x32_bf16 v[212:215], v[108:111], v[136:139], v[212:215]
    ds_read_b128 v[72:75], v14 offset:704
    v_mfma_f32_16x16x32_bf16 v[216:219], v[108:111], v[140:143], v[216:219]
    ds_read_b128 v[76:79], v14 offset:192
    v_mfma_f32_16x16x32_bf16 v[220:223], v[108:111], v[144:147], v[220:223]
    ds_read_b64 v[20:21], v13 offset:704
    v_mfma_f32_16x16x32_bf16 v[224:227], v[108:111], v[148:151], v[224:227]
    ds_read_b64 v[22:23], v13 offset:712
    v_mfma_f32_16x16x32_bf16 v[228:231], v[108:111], v[152:155], v[228:231]
    ds_read_b64 v[24:25], v13 offset:1216
    v_mfma_f32_16x16x32_bf16 v[232:235], v[108:111], v[156:159], v[232:235]
    ds_read_b64 v[26:27], v13 offset:1224
    v_mfma_f32_16x16x32_bf16 v[236:239], v[108:111], v[160:163], v[236:239]
    ds_read_b64 v[28:29], v13 offset:1728
    v_mfma_f32_16x16x32_bf16 v[216:219], v[112:115], v[136:139], v[216:219]
    ds_read_b64 v[30:31], v13 offset:1736
    v_mfma_f32_16x16x32_bf16 v[220:223], v[112:115], v[140:143], v[220:223]
    ds_read_b64 v[32:33], v13 offset:2240
    v_mfma_f32_16x16x32_bf16 v[224:227], v[112:115], v[144:147], v[224:227]
    ds_read_b64 v[34:35], v13 offset:2248
    v_mfma_f32_16x16x32_bf16 v[228:231], v[112:115], v[148:151], v[228:231]
    ds_read_b64 v[36:37], v13 offset:2752
    v_mfma_f32_16x16x32_bf16 v[232:235], v[112:115], v[152:155], v[232:235]
    ds_read_b64 v[38:39], v13 offset:2760
    v_mfma_f32_16x16x32_bf16 v[236:239], v[112:115], v[156:159], v[236:239]
    ds_read_b64 v[40:41], v13 offset:3264
    v_mfma_f32_16x16x32_bf16 v[220:223], v[116:119], v[136:139], v[220:223]
    ds_read_b64 v[42:43], v13 offset:3272
    v_mfma_f32_16x16x32_bf16 v[224:227], v[116:119], v[140:143], v[224:227]
    ds_read_b64 v[44:45], v13 offset:3776
    v_mfma_f32_16x16x32_bf16 v[228:231], v[116:119], v[144:147], v[228:231]
    ds_read_b64 v[46:47], v13 offset:3784
    v_mfma_f32_16x16x32_bf16 v[232:235], v[116:119], v[148:151], v[232:235]
    v_mfma_f32_16x16x32_bf16 v[236:239], v[116:119], v[152:155], v[236:239]
    v_mfma_f32_16x16x32_bf16 v[224:227], v[120:123], v[136:139], v[224:227]
    v_mfma_f32_16x16x32_bf16 v[228:231], v[120:123], v[140:143], v[228:231]
    v_mfma_f32_16x16x32_bf16 v[232:235], v[120:123], v[144:147], v[232:235]
    v_mfma_f32_16x16x32_bf16 v[236:239], v[120:123], v[148:151], v[236:239]
    v_mfma_f32_16x16x32_bf16 v[228:231], v[124:127], v[136:139], v[228:231]
    v_mfma_f32_16x16x32_bf16 v[232:235], v[124:127], v[140:143], v[232:235]
    v_mfma_f32_16x16x32_bf16 v[236:239], v[124:127], v[144:147], v[236:239]
    v_mfma_f32_16x16x32_bf16 v[232:235], v[128:131], v[136:139], v[232:235]
    v_mfma_f32_16x16x32_bf16 v[236:239], v[128:131], v[140:143], v[236:239]
    v_mfma_f32_16x16x32_bf16 v[236:239], v[132:135], v[136:139], v[236:239]
    s_waitcnt lgkmcnt(0)
    buffer_load_dwordx2 v[90:91], v8, s[52:55], s63 offen
    v_mfma_f32_16x16x32_bf16 v[208:211], v[16:19], v[48:51], v[208:211]
    ds_read_b64 v[92:93], v11 offset:3584
    v_mfma_f32_16x16x32_bf16 v[212:215], v[16:19], v[52:55], v[212:215]
    ds_read_b64 v[94:95], v11 offset:3072
    v_mfma_f32_16x16x32_bf16 v[216:219], v[16:19], v[56:59], v[216:219]
    ds_read_b64 v[96:97], v11 offset:2560
    v_mfma_f32_16x16x32_bf16 v[220:223], v[16:19], v[60:63], v[220:223]
    ds_read_b64 v[98:99], v11 offset:2048
    v_mfma_f32_16x16x32_bf16 v[224:227], v[16:19], v[64:67], v[224:227]
    v_mfma_f32_16x16x32_bf16 v[228:231], v[16:19], v[68:71], v[228:231]
    v_mfma_f32_16x16x32_bf16 v[232:235], v[16:19], v[72:75], v[232:235]
    v_mfma_f32_16x16x32_bf16 v[236:239], v[16:19], v[76:79], v[236:239]
    v_mfma_f32_16x16x32_bf16 v[212:215], v[20:23], v[48:51], v[212:215]
    v_mfma_f32_16x16x32_bf16 v[216:219], v[20:23], v[52:55], v[216:219]
    v_mfma_f32_16x16x32_bf16 v[220:223], v[20:23], v[56:59], v[220:223]
    v_mfma_f32_16x16x32_bf16 v[224:227], v[20:23], v[60:63], v[224:227]
    v_mfma_f32_16x16x32_bf16 v[228:231], v[20:23], v[64:67], v[228:231]
    v_mfma_f32_16x16x32_bf16 v[232:235], v[20:23], v[68:71], v[232:235]
    v_mfma_f32_16x16x32_bf16 v[236:239], v[20:23], v[72:75], v[236:239]
    v_mfma_f32_16x16x32_bf16 v[216:219], v[24:27], v[48:51], v[216:219]
    v_mfma_f32_16x16x32_bf16 v[220:223], v[24:27], v[52:55], v[220:223]
    v_mfma_f32_16x16x32_bf16 v[224:227], v[24:27], v[56:59], v[224:227]
    v_mfma_f32_16x16x32_bf16 v[228:231], v[24:27], v[60:63], v[228:231]
    v_mfma_f32_16x16x32_bf16 v[232:235], v[24:27], v[64:67], v[232:235]
    v_mfma_f32_16x16x32_bf16 v[236:239], v[24:27], v[68:71], v[236:239]
    v_mfma_f32_16x16x32_bf16 v[220:223], v[28:31], v[48:51], v[220:223]
    v_mfma_f32_16x16x32_bf16 v[224:227], v[28:31], v[52:55], v[224:227]
    v_mfma_f32_16x16x32_bf16 v[228:231], v[28:31], v[56:59], v[228:231]
    v_mfma_f32_16x16x32_bf16 v[232:235], v[28:31], v[60:63], v[232:235]
    v_mfma_f32_16x16x32_bf16 v[236:239], v[28:31], v[64:67], v[236:239]
    v_mfma_f32_16x16x32_bf16 v[224:227], v[32:35], v[48:51], v[224:227]
    v_mfma_f32_16x16x32_bf16 v[228:231], v[32:35], v[52:55], v[228:231]
    v_mfma_f32_16x16x32_bf16 v[232:235], v[32:35], v[56:59], v[232:235]
    v_mfma_f32_16x16x32_bf16 v[236:239], v[32:35], v[60:63], v[236:239]
    v_mfma_f32_16x16x32_bf16 v[228:231], v[36:39], v[48:51], v[228:231]
    v_mfma_f32_16x16x32_bf16 v[232:235], v[36:39], v[52:55], v[232:235]
    v_mfma_f32_16x16x32_bf16 v[236:239], v[36:39], v[56:59], v[236:239]
    v_mfma_f32_16x16x32_bf16 v[232:235], v[40:43], v[48:51], v[232:235]
    v_mfma_f32_16x16x32_bf16 v[236:239], v[40:43], v[52:55], v[236:239]
    v_mfma_f32_16x16x32_bf16 v[236:239], v[44:47], v[48:51], v[236:239]
    s_cmp_eq_u32 s33, 1
    s_cbranch_scc1 b2h1_22
    ds_write_b128 v7, v[224:227] offset:0
    ds_write_b128 v7, v[228:231] offset:1024
    s_nop 1
    ds_write_b128 v7, v[232:235] offset:2048
    s_nop 0
    ds_write_b128 v7, v[236:239] offset:3072
    v_mov_b64 v[192:193], v[208:209]
    v_mov_b64 v[194:195], v[210:211]
    v_mov_b64 v[196:197], v[212:213]
    v_mov_b64 v[198:199], v[214:215]
    v_mov_b64 v[200:201], v[216:217]
    v_mov_b64 v[202:203], v[218:219]
    v_mov_b64 v[204:205], v[220:221]
    v_mov_b64 v[206:207], v[222:223]
    s_branch b2x_23
b2h1_22:
    ds_write_b128 v7, v[208:211] offset:0
    ds_write_b128 v7, v[212:215] offset:1024
    ds_write_b128 v7, v[216:219] offset:2048
    ds_write_b128 v7, v[220:223] offset:3072
    v_mov_b64 v[192:193], v[224:225]
    v_mov_b64 v[194:195], v[226:227]
    v_mov_b64 v[196:197], v[228:229]
    v_mov_b64 v[198:199], v[230:231]
    v_mov_b64 v[200:201], v[232:233]
    v_mov_b64 v[202:203], v[234:235]
    v_mov_b64 v[204:205], v[236:237]
    v_mov_b64 v[206:207], v[238:239]
b2x_23:
    s_and_b32 s37, s37, 2
    s_lshl_b32 s37, s37, 3
    s_waitcnt lgkmcnt(0)
    s_lshr_b32 s39, s39, s37
    s_lshl_b32 s39, s39, 16
    v_and_b32 v16, 0xffff0000, v93
    v_lshlrev_b32 v17, 16, v93
    v_and_b32 v18, 0xffff0000, v92
    v_lshlrev_b32 v19, 16, v92
    v_and_b32 v20, 0xffff0000, v95
    v_lshlrev_b32 v21, 16, v95
    v_and_b32 v22, 0xffff0000, v94
    v_lshlrev_b32 v23, 16, v94
    v_and_b32 v24, 0xffff0000, v97
    v_lshlrev_b32 v25, 16, v97
    v_and_b32 v26, 0xffff0000, v96
    v_lshlrev_b32 v27, 16, v96
    v_and_b32 v28, 0xffff0000, v99
    v_lshlrev_b32 v29, 16, v99
    v_and_b32 v30, 0xffff0000, v98
    v_lshlrev_b32 v31, 16, v98
    v_fma_f32 v192, v16, s39, v192
    v_fma_f32 v193, v17, s39, v193
    v_fma_f32 v194, v18, s39, v194
    v_fma_f32 v195, v19, s39, v195
    v_fma_f32 v196, v20, s39, v196
    v_fma_f32 v197, v21, s39, v197
    v_fma_f32 v198, v22, s39, v198
    v_fma_f32 v199, v23, s39, v199
    v_fma_f32 v200, v24, s39, v200
    v_fma_f32 v201, v25, s39, v201
    v_fma_f32 v202, v26, s39, v202
    v_fma_f32 v203, v27, s39, v203
    v_fma_f32 v204, v28, s39, v204
    v_fma_f32 v205, v29, s39, v205
    v_fma_f32 v206, v30, s39, v206
    v_fma_f32 v207, v31, s39, v207
    s_barrier
    ds_read_b128 v[48:51], v6 offset:0
    ds_read_b128 v[52:55], v6 offset:1024
    ds_read_b128 v[56:59], v6 offset:2048
    ds_read_b128 v[60:63], v6 offset:3072
    s_waitcnt lgkmcnt(3)
    v_add_f32 v192, v192, v48
    v_add_f32 v193, v193, v49
    v_add_f32 v194, v194, v50
    v_add_f32 v195, v195, v51
    v_cvt_pk_bf16_f32 v64, v192, v193
    v_cvt_pk_bf16_f32 v65, v194, v195
    ds_write_b64 v9, v[64:65] offset:0
    s_waitcnt lgkmcnt(2)
    v_add_f32 v196, v196, v52
    v_add_f32 v197, v197, v53
    v_add_f32 v198, v198, v54
    v_add_f32 v199, v199, v55
    v_cvt_pk_bf16_f32 v66, v196, v197
    v_cvt_pk_bf16_f32 v67, v198, v199
    ds_write_b64 v9, v[66:67] offset:512
    s_waitcnt lgkmcnt(1)
    v_add_f32 v200, v200, v56
    v_add_f32 v201, v201, v57
    v_add_f32 v202, v202, v58
    v_add_f32 v203, v203, v59
    v_cvt_pk_bf16_f32 v68, v200, v201
    v_cvt_pk_bf16_f32 v69, v202, v203
    ds_write_b64 v9, v[68:69] offset:1024
    s_waitcnt lgkmcnt(0)
    v_add_f32 v204, v204, v60
    v_add_f32 v205, v205, v61
    v_add_f32 v206, v206, v62
    v_add_f32 v207, v207, v63
    v_cvt_pk_bf16_f32 v70, v204, v205
    v_cvt_pk_bf16_f32 v71, v206, v207
    ds_write_b64 v9, v[70:71] offset:1536
    s_waitcnt vmcnt(0)
    v_lshlrev_b32 v32, 16, v84
    v_and_b32 v33, 0xffff0000, v84
    v_lshlrev_b32 v34, 16, v85
    v_and_b32 v35, 0xffff0000, v85
    v_lshlrev_b32 v36, 16, v86
    v_and_b32 v37, 0xffff0000, v86
    v_lshlrev_b32 v38, 16, v87
    v_and_b32 v39, 0xffff0000, v87
    v_lshlrev_b32 v40, 16, v88
    v_and_b32 v41, 0xffff0000, v88
    v_lshlrev_b32 v42, 16, v89
    v_and_b32 v43, 0xffff0000, v89
    v_lshlrev_b32 v44, 16, v90
    v_and_b32 v45, 0xffff0000, v90
    v_lshlrev_b32 v46, 16, v91
    v_and_b32 v47, 0xffff0000, v91
    v_lshrrev_b32 v12, 2, v3
    v_mul_u32_u24 v12, 4160, v12
    v_and_b32 v13, 3, v3
    v_lshl_add_u32 v12, v13, 3, v12
    v_lshl_add_u32 v12, v4, 5, v12
    s_lshl_b32 s41, s29, 9
    v_add_u32 v12, s41, v12
    s_lshl_b32 s41, s29, 8
    v_add_u32 v13, s41, v1
    s_movk_i32 s42, 2304
    s_lshl_b32 s43, s90, 3
    s_add_u32 s43, s43, 1152
    v_mul_lo_u32 v13, v13, s42
    v_add_u32 v13, s43, v13
    s_mov_b32 s60, 0
    s_mov_b32 s61, 147456
    s_mov_b32 s62, 294912
    s_mov_b32 s63, 442368
    s_waitcnt lgkmcnt(0)
    s_barrier
    ds_read_b64_tr_b16 v[16:17], v12 offset:0
    ds_read_b64_tr_b16 v[18:19], v12 offset:128
    ds_read_b64_tr_b16 v[20:21], v12 offset:256
    ds_read_b64_tr_b16 v[22:23], v12 offset:384
    s_waitcnt lgkmcnt(3)
    v_lshlrev_b32 v48, 16, v16
    v_and_b32 v49, 0xffff0000, v16
    v_lshlrev_b32 v50, 16, v17
    v_and_b32 v51, 0xffff0000, v17
    v_mul_f32 v48, v48, v32
    v_mul_f32 v49, v49, v33
    v_mul_f32 v50, v50, v34
    v_mul_f32 v51, v51, v35
    v_cvt_pk_bf16_f32 v64, v48, v49
    v_cvt_pk_bf16_f32 v65, v50, v51
    buffer_store_dwordx2 v[64:65], v13, s[56:59], s60 offen
    s_waitcnt lgkmcnt(2)
    v_lshlrev_b32 v52, 16, v18
    v_and_b32 v53, 0xffff0000, v18
    v_lshlrev_b32 v54, 16, v19
    v_and_b32 v55, 0xffff0000, v19
    v_mul_f32 v52, v52, v36
    v_mul_f32 v53, v53, v37
    v_mul_f32 v54, v54, v38
    v_mul_f32 v55, v55, v39
    v_cvt_pk_bf16_f32 v66, v52, v53
    v_cvt_pk_bf16_f32 v67, v54, v55
    buffer_store_dwordx2 v[66:67], v13, s[56:59], s61 offen
    s_waitcnt lgkmcnt(1)
    v_lshlrev_b32 v56, 16, v20
    v_and_b32 v57, 0xffff0000, v20
    v_lshlrev_b32 v58, 16, v21
    v_and_b32 v59, 0xffff0000, v21
    v_mul_f32 v56, v56, v40
    v_mul_f32 v57, v57, v41
    v_mul_f32 v58, v58, v42
    v_mul_f32 v59, v59, v43
    v_cvt_pk_bf16_f32 v68, v56, v57
    v_cvt_pk_bf16_f32 v69, v58, v59
    buffer_store_dwordx2 v[68:69], v13, s[56:59], s62 offen
    s_waitcnt lgkmcnt(0)
    v_lshlrev_b32 v60, 16, v22
    v_and_b32 v61, 0xffff0000, v22
    v_lshlrev_b32 v62, 16, v23
    v_and_b32 v63, 0xffff0000, v23
    v_mul_f32 v60, v60, v44
    v_mul_f32 v61, v61, v45
    v_mul_f32 v62, v62, v46
    v_mul_f32 v63, v63, v47
    v_cvt_pk_bf16_f32 v70, v60, v61
    v_cvt_pk_bf16_f32 v71, v62, v63
    buffer_store_dwordx2 v[70:71], v13, s[56:59], s63 offen
    s_branch L_fin
L_bset:
    s_sub_u32 s91, s2, 176
    s_and_b32 s40, s91, 7
    s_lshr_b32 s89, s91, 3
    s_lshl_b32 s90, s40, 4
    s_add_u32 s90, s90, s89
    s_lshl_b32 s41, s40, 1
    s_add_u32 s41, s41, s89
    s_add_u32 s41, s41, 112
    s_cmp_lt_u32 s89, 16
    s_cselect_b32 s90, s90, s41
    s_mov_b32 s48, s4
    s_and_b32 s49, s5, 0xffff
    s_mov_b32 s50, 2359296
    s_mov_b32 s51, 0x00020000
    s_mov_b32 s52, s6
    s_and_b32 s53, s7, 0xffff
    s_mov_b32 s54, 1990656
    s_mov_b32 s55, 0x00020000
    s_cmp_ge_u32 s29, 8
    s_cbranch_scc1 bpf_24
    s_lshr_b32 s40, s91, 3
    s_and_b32 s96, s2, 7
    s_lshr_b32 s98, s96, 2
    s_and_b32 s96, s96, 3
    s_mul_i32 s98, s98, 1056
    s_mul_i32 s99, s40, 108
    s_add_u32 s98, s98, s99
    s_sub_u32 s98, s98, 16
    v_mov_b32 v5, 0x7fff0000
    s_movk_i32 s99, 1152
    v_add_u32 v4, s98, v1
    v_mul_lo_u32 v10, v4, s99
    v_cmp_gt_i32 vcc, 0, v4
    s_nop 1
    v_cndmask_b32 v10, v10, v5, vcc
    v_add_u32 v4, s98, v1
    v_add_u32 v4, 64, v4
    v_mul_lo_u32 v11, v4, s99
    v_cmp_gt_i32 vcc, 0, v4
    s_nop 1
    v_cndmask_b32 v11, v11, v5, vcc
    v_cmp_le_u32 vcc, 44, v1
    s_nop 1
    v_cndmask_b32 v11, v11, v5, vcc
    s_mul_i32 s99, s40, 58
    v_add_u32 v4, s99, v1
    v_mul_u32_u24 v6, 7282, v4
    v_lshrrev_b32 v6, 16, v6
    v_mul_u32_u24 v7, 9, v6
    v_sub_u32 v7, v4, v7
    v_mul_u32_u24 v8, 21846, v7
    v_lshrrev_b32 v8, 16, v8
    v_mul_u32_u24 v12, 3456, v6
    v_mul_u32_u24 v6, 1152, v8
    v_add_u32 v12, v12, v6
    v_mul_u32_u24 v8, 3, v8
    v_sub_u32 v7, v7, v8
    v_lshl_add_u32 v12, v7, 7, v12
    s_lshl_b32 s96, s96, 8
    v_add_u32 v12, s96, v12
    v_cmp_le_u32 vcc, 58, v1
    s_nop 1
    v_cndmask_b32 v12, v12, v5, vcc
    v_cmp_le_u32 vcc, 576, v4
    s_nop 1
    v_cndmask_b32 v12, v12, v5, vcc
    s_add_u32 s40, s29, 1
    s_lshl_b32 s96, s40, 7
    s_mul_i32 s97, s40, 221184
    buffer_load_dword v240, v12, s[52:55], s97 offen
    buffer_load_dword v241, v10, s[48:51], s96 offen
    buffer_load_dword v242, v11, s[48:51], s96 offen
bpf_24:
    s_cmp_lg_u32 s29, 7
    s_cbranch_scc1 tlb_26
    v_mov_b32 v20, s26
    v_mov_b32 v21, s27
    s_add_u32 s96, s12, 0
    s_addc_u32 s97, s13, 0
    v_writelane_b32 v20, s96, 0
    v_writelane_b32 v21, s97, 0
    s_add_u32 s96, s12, 2097152
    s_addc_u32 s97, s13, 0
    v_writelane_b32 v20, s96, 1
    v_writelane_b32 v21, s97, 1
    s_add_u32 s96, s12, 2359168
    s_addc_u32 s97, s13, 0
    v_writelane_b32 v20, s96, 2
    v_writelane_b32 v21, s97, 2
    s_add_u32 s96, s14, 0
    s_addc_u32 s97, s15, 0
    v_writelane_b32 v20, s96, 3
    v_writelane_b32 v21, s97, 3
    s_add_u32 s96, s14, 2097152
    s_addc_u32 s97, s15, 0
    v_writelane_b32 v20, s96, 4
    v_writelane_b32 v21, s97, 4
    s_add_u32 s96, s14, 2359168
    s_addc_u32 s97, s15, 0
    v_writelane_b32 v20, s96, 5
    v_writelane_b32 v21, s97, 5
    s_add_u32 s96, s10, 0
    s_addc_u32 s97, s11, 0
    v_writelane_b32 v20, s96, 6
    v_writelane_b32 v21, s97, 6
    s_add_u32 s96, s10, 2097152
    s_addc_u32 s97, s11, 0
    v_writelane_b32 v20, s96, 7
    v_writelane_b32 v21, s97, 7
    s_add_u32 s96, s10, 2359168
    s_addc_u32 s97, s11, 0
    v_writelane_b32 v20, s96, 8
    v_writelane_b32 v21, s97, 8
    s_add_u32 s96, s18, 0
    s_addc_u32 s97, s19, 0
    v_writelane_b32 v20, s96, 9
    v_writelane_b32 v21, s97, 9
    s_add_u32 s96, s18, 2097152
    s_addc_u32 s97, s19, 0
    v_writelane_b32 v20, s96, 10
    v_writelane_b32 v21, s97, 10
    s_add_u32 s96, s18, 2359168
    s_addc_u32 s97, s19, 0
    v_writelane_b32 v20, s96, 11
    v_writelane_b32 v21, s97, 11
    s_add_u32 s96, s8, 0
    s_addc_u32 s97, s9, 0
    v_writelane_b32 v20, s96, 12
    v_writelane_b32 v21, s97, 12
    s_add_u32 s96, s8, 663424
    s_addc_u32 s97, s9, 0
    v_writelane_b32 v20, s96, 13
    v_writelane_b32 v21, s97, 13
    s_add_u32 s96, s22, 0
    s_addc_u32 s97, s23, 0
    v_writelane_b32 v20, s96, 14
    v_writelane_b32 v21, s97, 14
    s_add_u32 s96, s22, 2097152
    s_addc_u32 s97, s23, 0
    v_writelane_b32 v20, s96, 15
    v_writelane_b32 v21, s97, 15
    s_add_u32 s96, s22, 4194304
    s_addc_u32 s97, s23, 0
    v_writelane_b32 v20, s96, 16
    v_writelane_b32 v21, s97, 16
    s_add_u32 s96, s22, 4718464
    s_addc_u32 s97, s23, 0
    v_writelane_b32 v20, s96, 17
    v_writelane_b32 v21, s97, 17
    s_add_u32 s96, s16, 0
    s_addc_u32 s97, s17, 0
    v_writelane_b32 v20, s96, 18
    v_writelane_b32 v21, s97, 18
    s_add_u32 s96, s20, 0
    s_addc_u32 s97, s21, 0
    v_writelane_b32 v20, s96, 19
    v_writelane_b32 v21, s97, 19
    s_add_u32 s96, s26, 0
    s_addc_u32 s97, s27, 0
    v_writelane_b32 v20, s96, 20
    v_writelane_b32 v21, s97, 20
    s_add_u32 s96, s26, 3145728
    s_addc_u32 s97, s27, 0
    v_writelane_b32 v20, s96, 21
    v_writelane_b32 v21, s97, 21
    s_add_u32 s96, s26, 4194304
    s_addc_u32 s97, s27, 0
    v_writelane_b32 v20, s96, 22
    v_writelane_b32 v21, s97, 22
    s_add_u32 s96, s26, 7340032
    s_addc_u32 s97, s27, 0
    v_writelane_b32 v20, s96, 23
    v_writelane_b32 v21, s97, 23
    s_add_u32 s96, s26, 8388608
    s_addc_u32 s97, s27, 0
    v_writelane_b32 v20, s96, 24
    v_writelane_b32 v21, s97, 24
    s_add_u32 s96, s26, 11534336
    s_addc_u32 s97, s27, 0
    v_writelane_b32 v20, s96, 25
    v_writelane_b32 v21, s97, 25
    s_add_u32 s96, s26, 12582912
    s_addc_u32 s97, s27, 0
    v_writelane_b32 v20, s96, 26
    v_writelane_b32 v21, s97, 26
    global_load_dword v245, v[20:21], off
tlb_26:
    s_cmp_lg_u32 s29, 0
    s_cbranch_scc1 nz_27
    s_mov_b32 s92, s24
    s_and_b32 s93, s25, 0xffff
    s_mov_b32 s94, 256
    s_mov_b32 s95, 0x00020000
    v_mov_b32 v254, s28
    v_mov_b32 v255, 0
    v_mov_b32 v251, 128
    s_mov_b64 exec, 1
    buffer_atomic_cmpswap v[254:255], v251, s[92:95], 0 offen sc0 sc1
    s_mov_b64 exec, -1
nz_27:
    s_and_b32 s32, s29, 3
    s_lshr_b32 s33, s29, 2
    s_lshl_b32 s34, s90, 2
    s_add_u32 s34, s34, s32
    s_lshl_b32 s35, s34, 12
    s_mul_i32 s36, s32, 21248
    s_add_u32 s44, s18, s35
    s_addc_u32 s45, s19, 0
    s_and_b32 s45, s45, 0xffff
    s_mov_b32 s46, 4096
    s_mov_b32 s47, 0x00020000
    s_lshl_b32 s37, s34, 1
    s_and_b32 s38, s37, 0xfffffffc
    s_load_dword s39, s[20:21], s38
    s_cmp_ge_u32 s91, 72
    s_cbranch_scc1 L_b_nob1
    s_cmp_ge_u32 s29, 4
    s_cbranch_scc1 L_b_aux
    s_mul_hi_u32 s66, s91, 0x1c71c71d
    s_mul_i32 s67, s66, 9
    s_sub_u32 s67, s91, s67
    v_and_b32 v2, 7, v0
    v_lshrrev_b32 v3, 3, v0
    s_lshl_b32 s40, s66, 8
    v_lshl_add_u32 v4, v3, 3, s40
    s_lshl_b32 s41, s67, 7
    v_lshl_add_u32 v5, v2, 4, s41
    s_movk_i32 s42, 1152
    v_mad_u32_u24 v6, v4, s42, v5
    v_add_u32 v7, 4608, v6
    v_subrev_u32 v8, 3456, v6
    v_subrev_u32 v9, 2304, v6
    v_subrev_u32 v10, 1152, v6
    s_mov_b32 s48, s12
    s_and_b32 s49, s13, 0xffff
    s_mov_b32 s50, 2359296
    s_mov_b32 s51, 0x00020000
    s_mov_b32 s52, s14
    s_and_b32 s53, s15, 0xffff
    s_mov_b32 s54, 2359296
    s_mov_b32 s55, 0x00020000
    s_mov_b32 s56, s16
    s_and_b32 s57, s17, 0xffff
    s_mov_b32 s58, 4608
    s_mov_b32 s59, 0x00020000
    buffer_load_dwordx4 v[16:19], v8, s[48:51], 0 offen
    buffer_load_dwordx4 v[20:23], v9, s[48:51], 0 offen
    buffer_load_dwordx4 v[24:27], v10, s[48:51], 0 offen
    buffer_load_dwordx4 v[28:31], v6, s[48:51], 0 offen offset:0
    buffer_load_dwordx4 v[32:35], v6, s[48:51], 0 offen offset:1152
    buffer_load_dwordx4 v[36:39], v6, s[48:51], 0 offen offset:2304
    buffer_load_dwordx4 v[40:43], v6, s[48:51], 0 offen offset:3456
    buffer_load_dwordx4 v[44:47], v7, s[48:51], 0 offen offset:0
    buffer_load_dwordx4 v[48:51], v7, s[48:51], 0 offen offset:1152
    buffer_load_dwordx4 v[52:55], v7, s[48:51], 0 offen offset:2304
    buffer_load_dwordx4 v[56:59], v7, s[48:51], 0 offen offset:3456
    buffer_load_dwordx4 v[60:63], v6, s[52:55], 0 offen offset:0
    buffer_load_dwordx4 v[64:67], v6, s[52:55], 0 offen offset:1152
    buffer_load_dwordx4 v[68:71], v6, s[52:55], 0 offen offset:2304
    buffer_load_dwordx4 v[72:75], v6, s[52:55], 0 offen offset:3456
    buffer_load_dwordx4 v[76:79], v7, s[52:55], 0 offen offset:0
    buffer_load_dwordx4 v[80:83], v7, s[52:55], 0 offen offset:1152
    buffer_load_dwordx4 v[84:87], v7, s[52:55], 0 offen offset:2304
    buffer_load_dwordx4 v[88:91], v7, s[52:55], 0 offen offset:3456
    s_lshl_b32 s43, s67, 9
    v_lshl_add_u32 v11, v2, 6, s43
    buffer_load_dwordx4 v[92:95], v11, s[56:59], 0 offen offset:0
    buffer_load_dwordx4 v[96:99], v11, s[56:59], 0 offen offset:16
    buffer_load_dwordx4 v[100:103], v11, s[56:59], 0 offen offset:32
    buffer_load_dwordx4 v[104:107], v11, s[56:59], 0 offen offset:48
    s_add_u32 s60, s26, 4096
    s_addc_u32 s61, s27, 0
    s_and_b32 s61, s61, 0xffff
    s_mov_b32 s62, 2359296
    s_mov_b32 s63, 0x00020000
    s_lshl_b32 s43, s67, 18
    v_lshl_add_u32 v12, v2, 15, s43
    v_lshlrev_b32 v14, 1, v4
    v_sub_u32 v12, v12, v14
    v_add_u32 v12, 4080, v12
    s_mov_b32 s68, 0
    s_mov_b32 s69, 4096
    s_mov_b32 s70, 8192
    s_mov_b32 s71, 12288
    s_mov_b32 s72, 16384
    s_mov_b32 s73, 20480
    s_mov_b32 s74, 24576
    s_mov_b32 s75, 28672
    s_waitcnt vmcnt(0)
    s_barrier
    v_lshlrev_b32 v108, 16, v92
    v_and_b32 v116, 0xffff0000, v92
    v_lshlrev_b32 v124, 16, v93
    v_and_b32 v132, 0xffff0000, v93
    v_lshlrev_b32 v109, 16, v94
    v_and_b32 v117, 0xffff0000, v94
    v_lshlrev_b32 v125, 16, v95
    v_and_b32 v133, 0xffff0000, v95
    v_lshlrev_b32 v110, 16, v96
    v_and_b32 v118, 0xffff0000, v96
    v_lshlrev_b32 v126, 16, v97
    v_and_b32 v134, 0xffff0000, v97
    v_lshlrev_b32 v111, 16, v98
    v_and_b32 v119, 0xffff0000, v98
    v_lshlrev_b32 v127, 16, v99
    v_and_b32 v135, 0xffff0000, v99
    v_lshlrev_b32 v112, 16, v100
    v_and_b32 v120, 0xffff0000, v100
    v_lshlrev_b32 v128, 16, v101
    v_and_b32 v136, 0xffff0000, v101
    v_lshlrev_b32 v113, 16, v102
    v_and_b32 v121, 0xffff0000, v102
    v_lshlrev_b32 v129, 16, v103
    v_and_b32 v137, 0xffff0000, v103
    v_lshlrev_b32 v114, 16, v104
    v_and_b32 v122, 0xffff0000, v104
    v_lshlrev_b32 v130, 16, v105
    v_and_b32 v138, 0xffff0000, v105
    v_lshlrev_b32 v115, 16, v106
    v_and_b32 v123, 0xffff0000, v106
    v_lshlrev_b32 v131, 16, v107
    v_and_b32 v139, 0xffff0000, v107
    v_lshlrev_b32 v140, 16, v16
    v_and_b32 v141, 0xffff0000, v16
    v_lshlrev_b32 v142, 16, v20
    v_and_b32 v143, 0xffff0000, v20
    v_lshlrev_b32 v144, 16, v24
    v_and_b32 v145, 0xffff0000, v24
    v_lshlrev_b32 v146, 16, v28
    v_and_b32 v147, 0xffff0000, v28
    v_lshlrev_b32 v148, 16, v32
    v_and_b32 v149, 0xffff0000, v32
    v_lshlrev_b32 v150, 16, v36
    v_and_b32 v151, 0xffff0000, v36
    v_lshlrev_b32 v152, 16, v40
    v_and_b32 v153, 0xffff0000, v40
    v_lshlrev_b32 v154, 16, v44
    v_and_b32 v155, 0xffff0000, v44
    v_lshlrev_b32 v156, 16, v48
    v_and_b32 v157, 0xffff0000, v48
    v_lshlrev_b32 v158, 16, v52
    v_and_b32 v159, 0xffff0000, v52
    v_lshlrev_b32 v160, 16, v56
    v_and_b32 v161, 0xffff0000, v56
    v_lshlrev_b32 v162, 16, v60
    v_and_b32 v163, 0xffff0000, v60
    v_lshlrev_b32 v164, 16, v64
    v_and_b32 v165, 0xffff0000, v64
    v_lshlrev_b32 v166, 16, v68
    v_and_b32 v167, 0xffff0000, v68
    v_lshlrev_b32 v168, 16, v72
    v_and_b32 v169, 0xffff0000, v72
    v_lshlrev_b32 v170, 16, v76
    v_and_b32 v171, 0xffff0000, v76
    v_lshlrev_b32 v172, 16, v80
    v_and_b32 v173, 0xffff0000, v80
    v_lshlrev_b32 v174, 16, v84
    v_and_b32 v175, 0xffff0000, v84
    v_lshlrev_b32 v176, 16, v88
    v_and_b32 v177, 0xffff0000, v88
    v_pk_mul_f32 v[178:179], v[132:133], v[140:141]
    v_pk_mul_f32 v[180:181], v[132:133], v[142:143]
    v_pk_mul_f32 v[182:183], v[132:133], v[144:145]
    v_pk_mul_f32 v[184:185], v[132:133], v[146:147]
    v_pk_mul_f32 v[186:187], v[132:133], v[148:149]
    v_pk_mul_f32 v[188:189], v[132:133], v[150:151]
    v_pk_mul_f32 v[190:191], v[132:133], v[152:153]
    v_pk_mul_f32 v[192:193], v[132:133], v[154:155]
    v_pk_fma_f32 v[178:179], v[124:125], v[142:143], v[178:179]
    v_pk_fma_f32 v[180:181], v[124:125], v[144:145], v[180:181]
    v_pk_fma_f32 v[182:183], v[124:125], v[146:147], v[182:183]
    v_pk_fma_f32 v[184:185], v[124:125], v[148:149], v[184:185]
    v_pk_fma_f32 v[186:187], v[124:125], v[150:151], v[186:187]
    v_pk_fma_f32 v[188:189], v[124:125], v[152:153], v[188:189]
    v_pk_fma_f32 v[190:191], v[124:125], v[154:155], v[190:191]
    v_pk_fma_f32 v[192:193], v[124:125], v[156:157], v[192:193]
    v_pk_fma_f32 v[178:179], v[116:117], v[144:145], v[178:179]
    v_pk_fma_f32 v[180:181], v[116:117], v[146:147], v[180:181]
    v_pk_fma_f32 v[182:183], v[116:117], v[148:149], v[182:183]
    v_pk_fma_f32 v[184:185], v[116:117], v[150:151], v[184:185]
    v_pk_fma_f32 v[186:187], v[116:117], v[152:153], v[186:187]
    v_pk_fma_f32 v[188:189], v[116:117], v[154:155], v[188:189]
    v_pk_fma_f32 v[190:191], v[116:117], v[156:157], v[190:191]
    v_pk_fma_f32 v[192:193], v[116:117], v[158:159], v[192:193]
    v_pk_fma_f32 v[178:179], v[108:109], v[146:147], v[178:179]
    v_pk_fma_f32 v[180:181], v[108:109], v[148:149], v[180:181]
    v_pk_fma_f32 v[182:183], v[108:109], v[150:151], v[182:183]
    v_pk_fma_f32 v[184:185], v[108:109], v[152:153], v[184:185]
    v_pk_fma_f32 v[186:187], v[108:109], v[154:155], v[186:187]
    v_pk_fma_f32 v[188:189], v[108:109], v[156:157], v[188:189]
    v_pk_fma_f32 v[190:191], v[108:109], v[158:159], v[190:191]
    v_pk_fma_f32 v[192:193], v[108:109], v[160:161], v[192:193]
    v_pk_mul_f32 v[178:179], v[178:179], v[162:163]
    v_pk_mul_f32 v[180:181], v[180:181], v[164:165]
    v_pk_mul_f32 v[182:183], v[182:183], v[166:167]
    v_pk_mul_f32 v[184:185], v[184:185], v[168:169]
    v_pk_mul_f32 v[186:187], v[186:187], v[170:171]
    v_pk_mul_f32 v[188:189], v[188:189], v[172:173]
    v_pk_mul_f32 v[190:191], v[190:191], v[174:175]
    v_pk_mul_f32 v[192:193], v[192:193], v[176:177]
    v_cvt_pk_bf16_f32 v194, v192, v190
    v_cvt_pk_bf16_f32 v195, v188, v186
    v_cvt_pk_bf16_f32 v196, v184, v182
    v_cvt_pk_bf16_f32 v197, v180, v178
    v_cvt_pk_bf16_f32 v198, v193, v191
    v_cvt_pk_bf16_f32 v199, v189, v187
    v_cvt_pk_bf16_f32 v200, v185, v183
    v_cvt_pk_bf16_f32 v201, v181, v179
    buffer_store_dwordx4 v[194:197], v12, s[60:63], s68 offen sc1
    buffer_store_dwordx4 v[198:201], v12, s[60:63], s69 offen sc1
    v_lshlrev_b32 v140, 16, v17
    v_and_b32 v141, 0xffff0000, v17
    v_lshlrev_b32 v142, 16, v21
    v_and_b32 v143, 0xffff0000, v21
    v_lshlrev_b32 v144, 16, v25
    v_and_b32 v145, 0xffff0000, v25
    v_lshlrev_b32 v146, 16, v29
    v_and_b32 v147, 0xffff0000, v29
    v_lshlrev_b32 v148, 16, v33
    v_and_b32 v149, 0xffff0000, v33
    v_lshlrev_b32 v150, 16, v37
    v_and_b32 v151, 0xffff0000, v37
    v_lshlrev_b32 v152, 16, v41
    v_and_b32 v153, 0xffff0000, v41
    v_lshlrev_b32 v154, 16, v45
    v_and_b32 v155, 0xffff0000, v45
    v_lshlrev_b32 v156, 16, v49
    v_and_b32 v157, 0xffff0000, v49
    v_lshlrev_b32 v158, 16, v53
    v_and_b32 v159, 0xffff0000, v53
    v_lshlrev_b32 v160, 16, v57
    v_and_b32 v161, 0xffff0000, v57
    v_lshlrev_b32 v162, 16, v61
    v_and_b32 v163, 0xffff0000, v61
    v_lshlrev_b32 v164, 16, v65
    v_and_b32 v165, 0xffff0000, v65
    v_lshlrev_b32 v166, 16, v69
    v_and_b32 v167, 0xffff0000, v69
    v_lshlrev_b32 v168, 16, v73
    v_and_b32 v169, 0xffff0000, v73
    v_lshlrev_b32 v170, 16, v77
    v_and_b32 v171, 0xffff0000, v77
    v_lshlrev_b32 v172, 16, v81
    v_and_b32 v173, 0xffff0000, v81
    v_lshlrev_b32 v174, 16, v85
    v_and_b32 v175, 0xffff0000, v85
    v_lshlrev_b32 v176, 16, v89
    v_and_b32 v177, 0xffff0000, v89
    v_pk_mul_f32 v[178:179], v[134:135], v[140:141]
    v_pk_mul_f32 v[180:181], v[134:135], v[142:143]
    v_pk_mul_f32 v[182:183], v[134:135], v[144:145]
    v_pk_mul_f32 v[184:185], v[134:135], v[146:147]
    v_pk_mul_f32 v[186:187], v[134:135], v[148:149]
    v_pk_mul_f32 v[188:189], v[134:135], v[150:151]
    v_pk_mul_f32 v[190:191], v[134:135], v[152:153]
    v_pk_mul_f32 v[192:193], v[134:135], v[154:155]
    v_pk_fma_f32 v[178:179], v[126:127], v[142:143], v[178:179]
    v_pk_fma_f32 v[180:181], v[126:127], v[144:145], v[180:181]
    v_pk_fma_f32 v[182:183], v[126:127], v[146:147], v[182:183]
    v_pk_fma_f32 v[184:185], v[126:127], v[148:149], v[184:185]
    v_pk_fma_f32 v[186:187], v[126:127], v[150:151], v[186:187]
    v_pk_fma_f32 v[188:189], v[126:127], v[152:153], v[188:189]
    v_pk_fma_f32 v[190:191], v[126:127], v[154:155], v[190:191]
    v_pk_fma_f32 v[192:193], v[126:127], v[156:157], v[192:193]
    v_pk_fma_f32 v[178:179], v[118:119], v[144:145], v[178:179]
    v_pk_fma_f32 v[180:181], v[118:119], v[146:147], v[180:181]
    v_pk_fma_f32 v[182:183], v[118:119], v[148:149], v[182:183]
    v_pk_fma_f32 v[184:185], v[118:119], v[150:151], v[184:185]
    v_pk_fma_f32 v[186:187], v[118:119], v[152:153], v[186:187]
    v_pk_fma_f32 v[188:189], v[118:119], v[154:155], v[188:189]
    v_pk_fma_f32 v[190:191], v[118:119], v[156:157], v[190:191]
    v_pk_fma_f32 v[192:193], v[118:119], v[158:159], v[192:193]
    v_pk_fma_f32 v[178:179], v[110:111], v[146:147], v[178:179]
    v_pk_fma_f32 v[180:181], v[110:111], v[148:149], v[180:181]
    v_pk_fma_f32 v[182:183], v[110:111], v[150:151], v[182:183]
    v_pk_fma_f32 v[184:185], v[110:111], v[152:153], v[184:185]
    v_pk_fma_f32 v[186:187], v[110:111], v[154:155], v[186:187]
    v_pk_fma_f32 v[188:189], v[110:111], v[156:157], v[188:189]
    v_pk_fma_f32 v[190:191], v[110:111], v[158:159], v[190:191]
    v_pk_fma_f32 v[192:193], v[110:111], v[160:161], v[192:193]
    v_pk_mul_f32 v[178:179], v[178:179], v[162:163]
    v_pk_mul_f32 v[180:181], v[180:181], v[164:165]
    v_pk_mul_f32 v[182:183], v[182:183], v[166:167]
    v_pk_mul_f32 v[184:185], v[184:185], v[168:169]
    v_pk_mul_f32 v[186:187], v[186:187], v[170:171]
    v_pk_mul_f32 v[188:189], v[188:189], v[172:173]
    v_pk_mul_f32 v[190:191], v[190:191], v[174:175]
    v_pk_mul_f32 v[192:193], v[192:193], v[176:177]
    v_cvt_pk_bf16_f32 v202, v192, v190
    v_cvt_pk_bf16_f32 v203, v188, v186
    v_cvt_pk_bf16_f32 v204, v184, v182
    v_cvt_pk_bf16_f32 v205, v180, v178
    v_cvt_pk_bf16_f32 v206, v193, v191
    v_cvt_pk_bf16_f32 v207, v189, v187
    v_cvt_pk_bf16_f32 v208, v185, v183
    v_cvt_pk_bf16_f32 v209, v181, v179
    buffer_store_dwordx4 v[202:205], v12, s[60:63], s70 offen sc1
    buffer_store_dwordx4 v[206:209], v12, s[60:63], s71 offen sc1
    v_lshlrev_b32 v140, 16, v18
    v_and_b32 v141, 0xffff0000, v18
    v_lshlrev_b32 v142, 16, v22
    v_and_b32 v143, 0xffff0000, v22
    v_lshlrev_b32 v144, 16, v26
    v_and_b32 v145, 0xffff0000, v26
    v_lshlrev_b32 v146, 16, v30
    v_and_b32 v147, 0xffff0000, v30
    v_lshlrev_b32 v148, 16, v34
    v_and_b32 v149, 0xffff0000, v34
    v_lshlrev_b32 v150, 16, v38
    v_and_b32 v151, 0xffff0000, v38
    v_lshlrev_b32 v152, 16, v42
    v_and_b32 v153, 0xffff0000, v42
    v_lshlrev_b32 v154, 16, v46
    v_and_b32 v155, 0xffff0000, v46
    v_lshlrev_b32 v156, 16, v50
    v_and_b32 v157, 0xffff0000, v50
    v_lshlrev_b32 v158, 16, v54
    v_and_b32 v159, 0xffff0000, v54
    v_lshlrev_b32 v160, 16, v58
    v_and_b32 v161, 0xffff0000, v58
    v_lshlrev_b32 v162, 16, v62
    v_and_b32 v163, 0xffff0000, v62
    v_lshlrev_b32 v164, 16, v66
    v_and_b32 v165, 0xffff0000, v66
    v_lshlrev_b32 v166, 16, v70
    v_and_b32 v167, 0xffff0000, v70
    v_lshlrev_b32 v168, 16, v74
    v_and_b32 v169, 0xffff0000, v74
    v_lshlrev_b32 v170, 16, v78
    v_and_b32 v171, 0xffff0000, v78
    v_lshlrev_b32 v172, 16, v82
    v_and_b32 v173, 0xffff0000, v82
    v_lshlrev_b32 v174, 16, v86
    v_and_b32 v175, 0xffff0000, v86
    v_lshlrev_b32 v176, 16, v90
    v_and_b32 v177, 0xffff0000, v90
    v_pk_mul_f32 v[178:179], v[136:137], v[140:141]
    v_pk_mul_f32 v[180:181], v[136:137], v[142:143]
    v_pk_mul_f32 v[182:183], v[136:137], v[144:145]
    v_pk_mul_f32 v[184:185], v[136:137], v[146:147]
    v_pk_mul_f32 v[186:187], v[136:137], v[148:149]
    v_pk_mul_f32 v[188:189], v[136:137], v[150:151]
    v_pk_mul_f32 v[190:191], v[136:137], v[152:153]
    v_pk_mul_f32 v[192:193], v[136:137], v[154:155]
    v_pk_fma_f32 v[178:179], v[128:129], v[142:143], v[178:179]
    v_pk_fma_f32 v[180:181], v[128:129], v[144:145], v[180:181]
    v_pk_fma_f32 v[182:183], v[128:129], v[146:147], v[182:183]
    v_pk_fma_f32 v[184:185], v[128:129], v[148:149], v[184:185]
    v_pk_fma_f32 v[186:187], v[128:129], v[150:151], v[186:187]
    v_pk_fma_f32 v[188:189], v[128:129], v[152:153], v[188:189]
    v_pk_fma_f32 v[190:191], v[128:129], v[154:155], v[190:191]
    v_pk_fma_f32 v[192:193], v[128:129], v[156:157], v[192:193]
    v_pk_fma_f32 v[178:179], v[120:121], v[144:145], v[178:179]
    v_pk_fma_f32 v[180:181], v[120:121], v[146:147], v[180:181]
    v_pk_fma_f32 v[182:183], v[120:121], v[148:149], v[182:183]
    v_pk_fma_f32 v[184:185], v[120:121], v[150:151], v[184:185]
    v_pk_fma_f32 v[186:187], v[120:121], v[152:153], v[186:187]
    v_pk_fma_f32 v[188:189], v[120:121], v[154:155], v[188:189]
    v_pk_fma_f32 v[190:191], v[120:121], v[156:157], v[190:191]
    v_pk_fma_f32 v[192:193], v[120:121], v[158:159], v[192:193]
    v_pk_fma_f32 v[178:179], v[112:113], v[146:147], v[178:179]
    v_pk_fma_f32 v[180:181], v[112:113], v[148:149], v[180:181]
    v_pk_fma_f32 v[182:183], v[112:113], v[150:151], v[182:183]
    v_pk_fma_f32 v[184:185], v[112:113], v[152:153], v[184:185]
    v_pk_fma_f32 v[186:187], v[112:113], v[154:155], v[186:187]
    v_pk_fma_f32 v[188:189], v[112:113], v[156:157], v[188:189]
    v_pk_fma_f32 v[190:191], v[112:113], v[158:159], v[190:191]
    v_pk_fma_f32 v[192:193], v[112:113], v[160:161], v[192:193]
    v_pk_mul_f32 v[178:179], v[178:179], v[162:163]
    v_pk_mul_f32 v[180:181], v[180:181], v[164:165]
    v_pk_mul_f32 v[182:183], v[182:183], v[166:167]
    v_pk_mul_f32 v[184:185], v[184:185], v[168:169]
    v_pk_mul_f32 v[186:187], v[186:187], v[170:171]
    v_pk_mul_f32 v[188:189], v[188:189], v[172:173]
    v_pk_mul_f32 v[190:191], v[190:191], v[174:175]
    v_pk_mul_f32 v[192:193], v[192:193], v[176:177]
    v_cvt_pk_bf16_f32 v194, v192, v190
    v_cvt_pk_bf16_f32 v195, v188, v186
    v_cvt_pk_bf16_f32 v196, v184, v182
    v_cvt_pk_bf16_f32 v197, v180, v178
    v_cvt_pk_bf16_f32 v198, v193, v191
    v_cvt_pk_bf16_f32 v199, v189, v187
    v_cvt_pk_bf16_f32 v200, v185, v183
    v_cvt_pk_bf16_f32 v201, v181, v179
    buffer_store_dwordx4 v[194:197], v12, s[60:63], s72 offen sc1
    buffer_store_dwordx4 v[198:201], v12, s[60:63], s73 offen sc1
    v_lshlrev_b32 v140, 16, v19
    v_and_b32 v141, 0xffff0000, v19
    v_lshlrev_b32 v142, 16, v23
    v_and_b32 v143, 0xffff0000, v23
    v_lshlrev_b32 v144, 16, v27
    v_and_b32 v145, 0xffff0000, v27
    v_lshlrev_b32 v146, 16, v31
    v_and_b32 v147, 0xffff0000, v31
    v_lshlrev_b32 v148, 16, v35
    v_and_b32 v149, 0xffff0000, v35
    v_lshlrev_b32 v150, 16, v39
    v_and_b32 v151, 0xffff0000, v39
    v_lshlrev_b32 v152, 16, v43
    v_and_b32 v153, 0xffff0000, v43
    v_lshlrev_b32 v154, 16, v47
    v_and_b32 v155, 0xffff0000, v47
    v_lshlrev_b32 v156, 16, v51
    v_and_b32 v157, 0xffff0000, v51
    v_lshlrev_b32 v158, 16, v55
    v_and_b32 v159, 0xffff0000, v55
    v_lshlrev_b32 v160, 16, v59
    v_and_b32 v161, 0xffff0000, v59
    v_lshlrev_b32 v162, 16, v63
    v_and_b32 v163, 0xffff0000, v63
    v_lshlrev_b32 v164, 16, v67
    v_and_b32 v165, 0xffff0000, v67
    v_lshlrev_b32 v166, 16, v71
    v_and_b32 v167, 0xffff0000, v71
    v_lshlrev_b32 v168, 16, v75
    v_and_b32 v169, 0xffff0000, v75
    v_lshlrev_b32 v170, 16, v79
    v_and_b32 v171, 0xffff0000, v79
    v_lshlrev_b32 v172, 16, v83
    v_and_b32 v173, 0xffff0000, v83
    v_lshlrev_b32 v174, 16, v87
    v_and_b32 v175, 0xffff0000, v87
    v_lshlrev_b32 v176, 16, v91
    v_and_b32 v177, 0xffff0000, v91
    v_pk_mul_f32 v[178:179], v[138:139], v[140:141]
    v_pk_mul_f32 v[180:181], v[138:139], v[142:143]
    v_pk_mul_f32 v[182:183], v[138:139], v[144:145]
    v_pk_mul_f32 v[184:185], v[138:139], v[146:147]
    v_pk_mul_f32 v[186:187], v[138:139], v[148:149]
    v_pk_mul_f32 v[188:189], v[138:139], v[150:151]
    v_pk_mul_f32 v[190:191], v[138:139], v[152:153]
    v_pk_mul_f32 v[192:193], v[138:139], v[154:155]
    v_pk_fma_f32 v[178:179], v[130:131], v[142:143], v[178:179]
    v_pk_fma_f32 v[180:181], v[130:131], v[144:145], v[180:181]
    v_pk_fma_f32 v[182:183], v[130:131], v[146:147], v[182:183]
    v_pk_fma_f32 v[184:185], v[130:131], v[148:149], v[184:185]
    v_pk_fma_f32 v[186:187], v[130:131], v[150:151], v[186:187]
    v_pk_fma_f32 v[188:189], v[130:131], v[152:153], v[188:189]
    v_pk_fma_f32 v[190:191], v[130:131], v[154:155], v[190:191]
    v_pk_fma_f32 v[192:193], v[130:131], v[156:157], v[192:193]
    v_pk_fma_f32 v[178:179], v[122:123], v[144:145], v[178:179]
    v_pk_fma_f32 v[180:181], v[122:123], v[146:147], v[180:181]
    v_pk_fma_f32 v[182:183], v[122:123], v[148:149], v[182:183]
    v_pk_fma_f32 v[184:185], v[122:123], v[150:151], v[184:185]
    v_pk_fma_f32 v[186:187], v[122:123], v[152:153], v[186:187]
    v_pk_fma_f32 v[188:189], v[122:123], v[154:155], v[188:189]
    v_pk_fma_f32 v[190:191], v[122:123], v[156:157], v[190:191]
    v_pk_fma_f32 v[192:193], v[122:123], v[158:159], v[192:193]
    v_pk_fma_f32 v[178:179], v[114:115], v[146:147], v[178:179]
    v_pk_fma_f32 v[180:181], v[114:115], v[148:149], v[180:181]
    v_pk_fma_f32 v[182:183], v[114:115], v[150:151], v[182:183]
    v_pk_fma_f32 v[184:185], v[114:115], v[152:153], v[184:185]
    v_pk_fma_f32 v[186:187], v[114:115], v[154:155], v[186:187]
    v_pk_fma_f32 v[188:189], v[114:115], v[156:157], v[188:189]
    v_pk_fma_f32 v[190:191], v[114:115], v[158:159], v[190:191]
    v_pk_fma_f32 v[192:193], v[114:115], v[160:161], v[192:193]
    v_pk_mul_f32 v[178:179], v[178:179], v[162:163]
    v_pk_mul_f32 v[180:181], v[180:181], v[164:165]
    v_pk_mul_f32 v[182:183], v[182:183], v[166:167]
    v_pk_mul_f32 v[184:185], v[184:185], v[168:169]
    v_pk_mul_f32 v[186:187], v[186:187], v[170:171]
    v_pk_mul_f32 v[188:189], v[188:189], v[172:173]
    v_pk_mul_f32 v[190:191], v[190:191], v[174:175]
    v_pk_mul_f32 v[192:193], v[192:193], v[176:177]
    v_cvt_pk_bf16_f32 v202, v192, v190
    v_cvt_pk_bf16_f32 v203, v188, v186
    v_cvt_pk_bf16_f32 v204, v184, v182
    v_cvt_pk_bf16_f32 v205, v180, v178
    v_cvt_pk_bf16_f32 v206, v193, v191
    v_cvt_pk_bf16_f32 v207, v189, v187
    v_cvt_pk_bf16_f32 v208, v185, v183
    v_cvt_pk_bf16_f32 v209, v181, v179
    buffer_store_dwordx4 v[202:205], v12, s[60:63], s74 offen sc1
    buffer_store_dwordx4 v[206:209], v12, s[60:63], s75 offen sc1
    s_branch L_b_join
L_b_aux:
    s_barrier
    v_lshlrev_b32 v180, 4, v1
    v_add_u32 v181, 4, v180
    v_add_u32 v182, 8, v180
    buffer_load_dwordx4 v[130:133], v180, s[44:47], 0 offen offset:0
    buffer_load_dwordx4 v[134:137], v181, s[44:47], 0 offen offset:0
    buffer_load_dwordx4 v[138:141], v182, s[44:47], 0 offen offset:0
    buffer_load_dwordx4 v[142:145], v180, s[44:47], 0 offen offset:1024
    buffer_load_dwordx4 v[146:149], v181, s[44:47], 0 offen offset:1024
    buffer_load_dwordx4 v[150:153], v182, s[44:47], 0 offen offset:1024
    buffer_load_dwordx4 v[154:157], v180, s[44:47], 0 offen offset:2048
    buffer_load_dwordx4 v[158:161], v181, s[44:47], 0 offen offset:2048
    buffer_load_dwordx4 v[162:165], v182, s[44:47], 0 offen offset:2048
    buffer_load_dwordx4 v[166:169], v180, s[44:47], 0 offen offset:3072
    buffer_load_dwordx4 v[170:173], v181, s[44:47], 0 offen offset:3072
    buffer_load_dwordx4 v[174:177], v182, s[44:47], 0 offen offset:3072
    v_mov_b32 v183, 0
    buffer_load_dwordx2 v[178:179], v183, s[44:47], 0 offen
    s_mov_b32 s48, s10
    s_and_b32 s49, s11, 0xffff
    s_mov_b32 s50, 2359296
    s_mov_b32 s51, 0x00020000
    s_lshr_b32 s40, s91, 3
    s_lshl_b32 s40, s40, 2
    s_add_u32 s40, s40, s32
    s_mul_i32 s40, s40, 52
    v_add_u32 v10, s40, v1
    s_and_b32 s41, s2, 7
    s_lshl_b32 s41, s41, 7
    s_movk_i32 s42, 1152
    v_mul_lo_u32 v11, v10, s42
    v_add_u32 v11, s41, v11
    v_mov_b32 v12, 0x7fff0000
    v_cmp_le_u32 vcc, 52, v1
    s_nop 1
    v_cndmask_b32 v11, v11, v12, vcc
    buffer_load_dword v243, v11, s[48:51], 0 offen
    v_subrev_u32 v12, s41, v11
    v_add_u32 v12, 1024, v12
    buffer_load_dword v244, v12, s[48:51], 0 offen
    s_waitcnt vmcnt(2)
    v_add_u32 v181, s36, v180
    v_alignbit_b32 v100, v134, v130, 16
    v_alignbit_b32 v101, v135, v131, 16
    v_alignbit_b32 v102, v136, v132, 16
    v_alignbit_b32 v103, v137, v133, 16
    v_alignbit_b32 v104, v138, v134, 16
    v_alignbit_b32 v105, v139, v135, 16
    v_alignbit_b32 v106, v140, v136, 16
    v_alignbit_b32 v107, v141, v137, 16
    ds_write_b128 v181, v[130:133] offset:32
    ds_write_b128 v181, v[100:103] offset:4192
    ds_write_b128 v181, v[134:137] offset:8352
    ds_write_b128 v181, v[104:107] offset:12512
    v_alignbit_b32 v100, v146, v142, 16
    v_alignbit_b32 v101, v147, v143, 16
    v_alignbit_b32 v102, v148, v144, 16
    v_alignbit_b32 v103, v149, v145, 16
    v_alignbit_b32 v104, v150, v146, 16
    v_alignbit_b32 v105, v151, v147, 16
    v_alignbit_b32 v106, v152, v148, 16
    v_alignbit_b32 v107, v153, v149, 16
    ds_write_b128 v181, v[142:145] offset:1056
    ds_write_b128 v181, v[100:103] offset:5216
    ds_write_b128 v181, v[146:149] offset:9376
    ds_write_b128 v181, v[104:107] offset:13536
    v_alignbit_b32 v100, v158, v154, 16
    v_alignbit_b32 v101, v159, v155, 16
    v_alignbit_b32 v102, v160, v156, 16
    v_alignbit_b32 v103, v161, v157, 16
    v_alignbit_b32 v104, v162, v158, 16
    v_alignbit_b32 v105, v163, v159, 16
    v_alignbit_b32 v106, v164, v160, 16
    v_alignbit_b32 v107, v165, v161, 16
    ds_write_b128 v181, v[154:157] offset:2080
    ds_write_b128 v181, v[100:103] offset:6240
    ds_write_b128 v181, v[158:161] offset:10400
    ds_write_b128 v181, v[104:107] offset:14560
    v_alignbit_b32 v100, v170, v166, 16
    v_alignbit_b32 v101, v171, v167, 16
    v_alignbit_b32 v102, v172, v168, 16
    v_alignbit_b32 v103, v173, v169, 16
    v_alignbit_b32 v104, v174, v170, 16
    v_alignbit_b32 v105, v175, v171, 16
    v_alignbit_b32 v106, v176, v172, 16
    v_alignbit_b32 v107, v177, v173, 16
    ds_write_b128 v181, v[166:169] offset:3104
    ds_write_b128 v181, v[100:103] offset:7264
    ds_write_b128 v181, v[170:173] offset:11424
    ds_write_b128 v181, v[104:107] offset:15584
    v_lshlrev_b32 v108, 16, v178
    v_alignbit_b32 v109, v179, v178, 16
    v_mov_b64 v[110:111], 0
    v_mov_b64 v[112:113], 0
    v_mov_b64 v[114:115], 0
    v_mov_b64 v[116:117], 0
    v_cmp_eq_u32 s[60:61], 1, v1
    v_cmp_eq_u32 s[62:63], 2, v1
    v_cmp_eq_u32 s[64:65], 3, v1
    v_cndmask_b32 v117, v117, v108, s[60:61]
    v_cndmask_b32 v117, v117, v178, s[62:63]
    v_cndmask_b32 v117, v117, v109, s[64:65]
    v_cndmask_b32 v116, v116, v108, s[64:65]
    v_mul_u32_u24 v182, 4160, v1
    v_add_u32 v182, s36, v182
    s_mov_b64 exec, 0xf
    ds_write_b128 v182, v[110:113]
    ds_write_b128 v182, v[114:117] offset:16
    s_mov_b64 exec, 0xffffffff
    v_lshlrev_b32 v182, 4, v1
    v_add_u32 v182, s36, v182
    ds_write_b128 v182, v[110:113] offset:20736
    s_mov_b64 exec, -1
L_b_join:
    s_waitcnt vmcnt(0) lgkmcnt(0)
    s_barrier
    s_cmp_lg_u32 s29, 0
    s_cbranch_scc1 b1f_28
    v_readfirstlane_b32 s31, v254
    s_nop 0
    s_cmp_eq_u32 s31, 0
    s_cselect_b32 s31, s28, s31
    s_lshl_b32 s40, s67, 8
    s_lshl_b32 s41, s66, 2
    s_add_u32 s40, s40, s41
    s_add_u32 s92, s26, 12652544
    s_addc_u32 s93, s27, 0
    s_and_b32 s93, s93, 0xffff
    s_mov_b32 s94, 65536
    s_mov_b32 s95, 0x00020000
    v_mov_b32 v250, s40
    v_mov_b32 v251, s31
    s_mov_b64 exec, 1
    buffer_store_dword v251, v250, s[92:95], 0 offen sc1
    s_mov_b64 exec, -1
b1f_28:
    s_branch L_b_b2
L_b_nob1:
    s_cmp_lt_u32 s29, 4
    s_cbranch_scc1 bnx_29
    v_lshlrev_b32 v180, 4, v1
    v_add_u32 v181, 4, v180
    v_add_u32 v182, 8, v180
    buffer_load_dwordx4 v[130:133], v180, s[44:47], 0 offen offset:0
    buffer_load_dwordx4 v[134:137], v181, s[44:47], 0 offen offset:0
    buffer_load_dwordx4 v[138:141], v182, s[44:47], 0 offen offset:0
    buffer_load_dwordx4 v[142:145], v180, s[44:47], 0 offen offset:1024
    buffer_load_dwordx4 v[146:149], v181, s[44:47], 0 offen offset:1024
    buffer_load_dwordx4 v[150:153], v182, s[44:47], 0 offen offset:1024
    buffer_load_dwordx4 v[154:157], v180, s[44:47], 0 offen offset:2048
    buffer_load_dwordx4 v[158:161], v181, s[44:47], 0 offen offset:2048
    buffer_load_dwordx4 v[162:165], v182, s[44:47], 0 offen offset:2048
    buffer_load_dwordx4 v[166:169], v180, s[44:47], 0 offen offset:3072
    buffer_load_dwordx4 v[170:173], v181, s[44:47], 0 offen offset:3072
    buffer_load_dwordx4 v[174:177], v182, s[44:47], 0 offen offset:3072
    v_mov_b32 v183, 0
    buffer_load_dwordx2 v[178:179], v183, s[44:47], 0 offen
    s_mov_b32 s48, s10
    s_and_b32 s49, s11, 0xffff
    s_mov_b32 s50, 2359296
    s_mov_b32 s51, 0x00020000
    s_lshr_b32 s40, s91, 3
    s_lshl_b32 s40, s40, 2
    s_add_u32 s40, s40, s32
    s_mul_i32 s40, s40, 52
    v_add_u32 v10, s40, v1
    s_and_b32 s41, s2, 7
    s_lshl_b32 s41, s41, 7
    s_movk_i32 s42, 1152
    v_mul_lo_u32 v11, v10, s42
    v_add_u32 v11, s41, v11
    v_mov_b32 v12, 0x7fff0000
    v_cmp_le_u32 vcc, 52, v1
    s_nop 1
    v_cndmask_b32 v11, v11, v12, vcc
    buffer_load_dword v243, v11, s[48:51], 0 offen
    v_subrev_u32 v12, s41, v11
    v_add_u32 v12, 1024, v12
    buffer_load_dword v244, v12, s[48:51], 0 offen
    s_waitcnt vmcnt(2)
    v_add_u32 v181, s36, v180
    v_alignbit_b32 v100, v134, v130, 16
    v_alignbit_b32 v101, v135, v131, 16
    v_alignbit_b32 v102, v136, v132, 16
    v_alignbit_b32 v103, v137, v133, 16
    v_alignbit_b32 v104, v138, v134, 16
    v_alignbit_b32 v105, v139, v135, 16
    v_alignbit_b32 v106, v140, v136, 16
    v_alignbit_b32 v107, v141, v137, 16
    ds_write_b128 v181, v[130:133] offset:32
    ds_write_b128 v181, v[100:103] offset:4192
    ds_write_b128 v181, v[134:137] offset:8352
    ds_write_b128 v181, v[104:107] offset:12512
    v_alignbit_b32 v100, v146, v142, 16
    v_alignbit_b32 v101, v147, v143, 16
    v_alignbit_b32 v102, v148, v144, 16
    v_alignbit_b32 v103, v149, v145, 16
    v_alignbit_b32 v104, v150, v146, 16
    v_alignbit_b32 v105, v151, v147, 16
    v_alignbit_b32 v106, v152, v148, 16
    v_alignbit_b32 v107, v153, v149, 16
    ds_write_b128 v181, v[142:145] offset:1056
    ds_write_b128 v181, v[100:103] offset:5216
    ds_write_b128 v181, v[146:149] offset:9376
    ds_write_b128 v181, v[104:107] offset:13536
    v_alignbit_b32 v100, v158, v154, 16
    v_alignbit_b32 v101, v159, v155, 16
    v_alignbit_b32 v102, v160, v156, 16
    v_alignbit_b32 v103, v161, v157, 16
    v_alignbit_b32 v104, v162, v158, 16
    v_alignbit_b32 v105, v163, v159, 16
    v_alignbit_b32 v106, v164, v160, 16
    v_alignbit_b32 v107, v165, v161, 16
    ds_write_b128 v181, v[154:157] offset:2080
    ds_write_b128 v181, v[100:103] offset:6240
    ds_write_b128 v181, v[158:161] offset:10400
    ds_write_b128 v181, v[104:107] offset:14560
    v_alignbit_b32 v100, v170, v166, 16
    v_alignbit_b32 v101, v171, v167, 16
    v_alignbit_b32 v102, v172, v168, 16
    v_alignbit_b32 v103, v173, v169, 16
    v_alignbit_b32 v104, v174, v170, 16
    v_alignbit_b32 v105, v175, v171, 16
    v_alignbit_b32 v106, v176, v172, 16
    v_alignbit_b32 v107, v177, v173, 16
    ds_write_b128 v181, v[166:169] offset:3104
    ds_write_b128 v181, v[100:103] offset:7264
    ds_write_b128 v181, v[170:173] offset:11424
    ds_write_b128 v181, v[104:107] offset:15584
    v_lshlrev_b32 v108, 16, v178
    v_alignbit_b32 v109, v179, v178, 16
    v_mov_b64 v[110:111], 0
    v_mov_b64 v[112:113], 0
    v_mov_b64 v[114:115], 0
    v_mov_b64 v[116:117], 0
    v_cmp_eq_u32 s[60:61], 1, v1
    v_cmp_eq_u32 s[62:63], 2, v1
    v_cmp_eq_u32 s[64:65], 3, v1
    v_cndmask_b32 v117, v117, v108, s[60:61]
    v_cndmask_b32 v117, v117, v178, s[62:63]
    v_cndmask_b32 v117, v117, v109, s[64:65]
    v_cndmask_b32 v116, v116, v108, s[64:65]
    v_mul_u32_u24 v182, 4160, v1
    v_add_u32 v182, s36, v182
    s_mov_b64 exec, 0xf
    ds_write_b128 v182, v[110:113]
    ds_write_b128 v182, v[114:117] offset:16
    s_mov_b64 exec, 0xffffffff
    v_lshlrev_b32 v182, 4, v1
    v_add_u32 v182, s36, v182
    ds_write_b128 v182, v[110:113] offset:20736
    s_mov_b64 exec, -1
bnx_29:
    s_waitcnt vmcnt(0)
    s_cmp_lg_u32 s29, 0
    s_cbranch_scc1 bz_30
    v_readfirstlane_b32 s31, v254
    s_nop 0
    s_cmp_eq_u32 s31, 0
    s_cselect_b32 s31, s28, s31
bz_30:
L_b_b2:
    s_add_u32 s48, s26, s35
    s_addc_u32 s49, s27, 0
    s_add_u32 s48, s48, 4096
    s_addc_u32 s49, s49, 0
    s_and_b32 s49, s49, 0xffff
    s_mov_b32 s50, 4096
    s_mov_b32 s51, 0x00020000
    s_mov_b32 s52, s10
    s_and_b32 s53, s11, 0xffff
    s_mov_b32 s54, 2359296
    s_mov_b32 s55, 0x00020000
    s_mov_b32 s56, s22
    s_and_b32 s57, s23, 0xffff
    s_mov_b32 s58, 4718592
    s_mov_b32 s59, 0x00020000
    v_and_b32 v3, 15, v1
    v_lshrrev_b32 v4, 4, v1
    v_lshlrev_b32 v5, 4, v1
    s_lshl_b32 s40, s33, 11
    v_add_u32 v5, s40, v5
    v_add_u32 v10, s36, v5
    v_lshlrev_b32 v9, 5, v3
    v_lshl_add_u32 v9, v4, 3, v9
    s_lshl_b32 s41, s29, 8
    v_add_u32 v8, s41, v1
    s_movk_i32 s42, 1152
    v_mul_lo_u32 v8, v8, s42
    s_lshl_b32 s43, s90, 3
    v_add_u32 v8, s43, v8
    v_add_u32 v12, 1, v3
    v_and_b32 v13, 3, v12
    v_lshrrev_b32 v12, 2, v12
    v_mul_u32_u24 v13, 4160, v13
    v_lshl_add_u32 v13, v4, 4, v13
    v_lshl_add_u32 v13, v12, 3, v13
    s_lshl_b32 s41, s33, 8
    s_add_u32 s41, s41, s36
    v_add_u32 v13, s41, v13
    v_lshlrev_b32 v14, 4, v4
    v_lshlrev_b32 v15, 5, v3
    v_sub_u32 v14, v14, v15
    v_add_u32 v14, 17120, v14
    v_add_u32 v14, s41, v14
    s_cmp_lg_u32 s29, 0
    s_cbranch_scc1 b2w_31
    s_lshr_b32 s41, s90, 4
    s_lshl_b32 s41, s41, 8
    s_add_u32 s92, s26, 12652544
    s_addc_u32 s93, s27, 0
    s_and_b32 s93, s93, 0xffff
    s_mov_b32 s94, 65536
    s_mov_b32 s95, 0x00020000
    v_and_b32 v250, 7, v1
    v_lshlrev_b32 v250, 2, v250
    v_add_u32 v250, s41, v250
    s_mov_b64 exec, 0xff
    s_mov_b32 s88, 1000000
poll_32:
    buffer_load_dword v251, v250, s[92:95], 0 offen sc1
    s_waitcnt vmcnt(0)
    v_cmp_ne_u32 vcc, s31, v251
    s_nop 4
    s_cbranch_vccz polld_33
    s_sleep 2
    s_sub_u32 s88, s88, 1
    s_cmp_lg_u32 s88, 0
    s_cbranch_scc1 poll_32
polld_33:
    s_mov_b64 exec, -1
b2w_31:
    s_barrier
    buffer_load_dwordx4 v[68:71], v5, s[48:51], 0 offen offset:0 sc1
    buffer_load_dwordx4 v[72:75], v5, s[48:51], 0 offen offset:1024 sc1
    s_lshl_b32 s41, s29, 12
    v_lshlrev_b32 v6, 4, v1
    v_add_u32 v6, 84992, v6
    v_add_u32 v7, s41, v6
    s_xor_b32 s42, s29, 4
    s_lshl_b32 s42, s42, 12
    v_add_u32 v6, s42, v6
    v_sub_u32 v11, 17144, v9
    s_lshl_b32 s41, s33, 11
    s_sub_u32 s42, s36, s41
    v_add_u32 v11, s42, v11
    s_mul_i32 s42, s32, 4160
    s_add_u32 s42, s42, s41
    v_add_u32 v9, s42, v9
    s_waitcnt vmcnt(0)
    ds_write_b128 v10, v[68:71] offset:16640
    ds_write_b128 v10, v[72:75] offset:17664
    s_mov_b32 s60, 0
    s_mov_b32 s61, 73728
    s_mov_b32 s62, 147456
    s_mov_b32 s63, 221184
    s_waitcnt lgkmcnt(0)
    s_barrier
    ds_read_b64 v[104:105], v13 offset:0
    ds_read_b64 v[106:107], v13 offset:8
    ds_read_b128 v[136:139], v14 offset:3584
    ds_read_b128 v[140:143], v14 offset:3072
    ds_read_b128 v[144:147], v14 offset:2560
    ds_read_b128 v[148:151], v14 offset:2048
    ds_read_b128 v[152:155], v14 offset:1536
    ds_read_b128 v[156:159], v14 offset:1024
    ds_read_b128 v[160:163], v14 offset:512
    ds_read_b128 v[164:167], v14 offset:0
    ds_read_b64 v[108:109], v13 offset:512
    ds_read_b64 v[110:111], v13 offset:520
    ds_read_b64 v[112:113], v13 offset:1024
    ds_read_b64 v[114:115], v13 offset:1032
    ds_read_b64 v[116:117], v13 offset:1536
    ds_read_b64 v[118:119], v13 offset:1544
    ds_read_b64 v[120:121], v13 offset:2048
    ds_read_b64 v[122:123], v13 offset:2056
    ds_read_b64 v[124:125], v13 offset:2560
    ds_read_b64 v[126:127], v13 offset:2568
    ds_read_b64 v[128:129], v13 offset:3072
    ds_read_b64 v[130:131], v13 offset:3080
    ds_read_b64 v[132:133], v13 offset:3584
    ds_read_b64 v[134:135], v13 offset:3592
    s_waitcnt lgkmcnt(0)
    buffer_load_dwordx2 v[84:85], v8, s[52:55], s60 offen
    v_mfma_f32_16x16x32_bf16 v[208:211], v[104:107], v[136:139], 0
    ds_read_b64 v[16:17], v13 offset:64
    v_mfma_f32_16x16x32_bf16 v[212:215], v[104:107], v[140:143], 0
    ds_read_b64 v[18:19], v13 offset:72
    v_mfma_f32_16x16x32_bf16 v[216:219], v[104:107], v[144:147], 0
    ds_read_b128 v[48:51], v14 offset:3648
    v_mfma_f32_16x16x32_bf16 v[220:223], v[104:107], v[148:151], 0
    ds_read_b128 v[52:55], v14 offset:3136
    v_mfma_f32_16x16x32_bf16 v[224:227], v[104:107], v[152:155], 0
    ds_read_b128 v[56:59], v14 offset:2624
    v_mfma_f32_16x16x32_bf16 v[228:231], v[104:107], v[156:159], 0
    ds_read_b128 v[60:63], v14 offset:2112
    v_mfma_f32_16x16x32_bf16 v[232:235], v[104:107], v[160:163], 0
    ds_read_b128 v[64:67], v14 offset:1600
    v_mfma_f32_16x16x32_bf16 v[236:239], v[104:107], v[164:167], 0
    ds_read_b128 v[68:71], v14 offset:1088
    v_mfma_f32_16x16x32_bf16 v[212:215], v[108:111], v[136:139], v[212:215]
    ds_read_b128 v[72:75], v14 offset:576
    v_mfma_f32_16x16x32_bf16 v[216:219], v[108:111], v[140:143], v[216:219]
    ds_read_b128 v[76:79], v14 offset:64
    v_mfma_f32_16x16x32_bf16 v[220:223], v[108:111], v[144:147], v[220:223]
    ds_read_b64 v[20:21], v13 offset:576
    v_mfma_f32_16x16x32_bf16 v[224:227], v[108:111], v[148:151], v[224:227]
    ds_read_b64 v[22:23], v13 offset:584
    v_mfma_f32_16x16x32_bf16 v[228:231], v[108:111], v[152:155], v[228:231]
    ds_read_b64 v[24:25], v13 offset:1088
    v_mfma_f32_16x16x32_bf16 v[232:235], v[108:111], v[156:159], v[232:235]
    ds_read_b64 v[26:27], v13 offset:1096
    v_mfma_f32_16x16x32_bf16 v[236:239], v[108:111], v[160:163], v[236:239]
    ds_read_b64 v[28:29], v13 offset:1600
    v_mfma_f32_16x16x32_bf16 v[216:219], v[112:115], v[136:139], v[216:219]
    ds_read_b64 v[30:31], v13 offset:1608
    v_mfma_f32_16x16x32_bf16 v[220:223], v[112:115], v[140:143], v[220:223]
    ds_read_b64 v[32:33], v13 offset:2112
    v_mfma_f32_16x16x32_bf16 v[224:227], v[112:115], v[144:147], v[224:227]
    ds_read_b64 v[34:35], v13 offset:2120
    v_mfma_f32_16x16x32_bf16 v[228:231], v[112:115], v[148:151], v[228:231]
    ds_read_b64 v[36:37], v13 offset:2624
    v_mfma_f32_16x16x32_bf16 v[232:235], v[112:115], v[152:155], v[232:235]
    ds_read_b64 v[38:39], v13 offset:2632
    v_mfma_f32_16x16x32_bf16 v[236:239], v[112:115], v[156:159], v[236:239]
    ds_read_b64 v[40:41], v13 offset:3136
    v_mfma_f32_16x16x32_bf16 v[220:223], v[116:119], v[136:139], v[220:223]
    ds_read_b64 v[42:43], v13 offset:3144
    v_mfma_f32_16x16x32_bf16 v[224:227], v[116:119], v[140:143], v[224:227]
    ds_read_b64 v[44:45], v13 offset:3648
    v_mfma_f32_16x16x32_bf16 v[228:231], v[116:119], v[144:147], v[228:231]
    ds_read_b64 v[46:47], v13 offset:3656
    v_mfma_f32_16x16x32_bf16 v[232:235], v[116:119], v[148:151], v[232:235]
    v_mfma_f32_16x16x32_bf16 v[236:239], v[116:119], v[152:155], v[236:239]
    v_mfma_f32_16x16x32_bf16 v[224:227], v[120:123], v[136:139], v[224:227]
    v_mfma_f32_16x16x32_bf16 v[228:231], v[120:123], v[140:143], v[228:231]
    v_mfma_f32_16x16x32_bf16 v[232:235], v[120:123], v[144:147], v[232:235]
    v_mfma_f32_16x16x32_bf16 v[236:239], v[120:123], v[148:151], v[236:239]
    v_mfma_f32_16x16x32_bf16 v[228:231], v[124:127], v[136:139], v[228:231]
    v_mfma_f32_16x16x32_bf16 v[232:235], v[124:127], v[140:143], v[232:235]
    v_mfma_f32_16x16x32_bf16 v[236:239], v[124:127], v[144:147], v[236:239]
    v_mfma_f32_16x16x32_bf16 v[232:235], v[128:131], v[136:139], v[232:235]
    v_mfma_f32_16x16x32_bf16 v[236:239], v[128:131], v[140:143], v[236:239]
    v_mfma_f32_16x16x32_bf16 v[236:239], v[132:135], v[136:139], v[236:239]
    s_waitcnt lgkmcnt(0)
    buffer_load_dwordx2 v[86:87], v8, s[52:55], s61 offen
    v_mfma_f32_16x16x32_bf16 v[208:211], v[16:19], v[48:51], v[208:211]
    ds_read_b64 v[104:105], v13 offset:128
    v_mfma_f32_16x16x32_bf16 v[212:215], v[16:19], v[52:55], v[212:215]
    ds_read_b64 v[106:107], v13 offset:136
    v_mfma_f32_16x16x32_bf16 v[216:219], v[16:19], v[56:59], v[216:219]
    ds_read_b128 v[136:139], v14 offset:3712
    v_mfma_f32_16x16x32_bf16 v[220:223], v[16:19], v[60:63], v[220:223]
    ds_read_b128 v[140:143], v14 offset:3200
    v_mfma_f32_16x16x32_bf16 v[224:227], v[16:19], v[64:67], v[224:227]
    ds_read_b128 v[144:147], v14 offset:2688
    v_mfma_f32_16x16x32_bf16 v[228:231], v[16:19], v[68:71], v[228:231]
    ds_read_b128 v[148:151], v14 offset:2176
    v_mfma_f32_16x16x32_bf16 v[232:235], v[16:19], v[72:75], v[232:235]
    ds_read_b128 v[152:155], v14 offset:1664
    v_mfma_f32_16x16x32_bf16 v[236:239], v[16:19], v[76:79], v[236:239]
    ds_read_b128 v[156:159], v14 offset:1152
    v_mfma_f32_16x16x32_bf16 v[212:215], v[20:23], v[48:51], v[212:215]
    ds_read_b128 v[160:163], v14 offset:640
    v_mfma_f32_16x16x32_bf16 v[216:219], v[20:23], v[52:55], v[216:219]
    ds_read_b128 v[164:167], v14 offset:128
    v_mfma_f32_16x16x32_bf16 v[220:223], v[20:23], v[56:59], v[220:223]
    ds_read_b64 v[108:109], v13 offset:640
    v_mfma_f32_16x16x32_bf16 v[224:227], v[20:23], v[60:63], v[224:227]
    ds_read_b64 v[110:111], v13 offset:648
    v_mfma_f32_16x16x32_bf16 v[228:231], v[20:23], v[64:67], v[228:231]
    ds_read_b64 v[112:113], v13 offset:1152
    v_mfma_f32_16x16x32_bf16 v[232:235], v[20:23], v[68:71], v[232:235]
    ds_read_b64 v[114:115], v13 offset:1160
    v_mfma_f32_16x16x32_bf16 v[236:239], v[20:23], v[72:75], v[236:239]
    ds_read_b64 v[116:117], v13 offset:1664
    v_mfma_f32_16x16x32_bf16 v[216:219], v[24:27], v[48:51], v[216:219]
    ds_read_b64 v[118:119], v13 offset:1672
    v_mfma_f32_16x16x32_bf16 v[220:223], v[24:27], v[52:55], v[220:223]
    ds_read_b64 v[120:121], v13 offset:2176
    v_mfma_f32_16x16x32_bf16 v[224:227], v[24:27], v[56:59], v[224:227]
    ds_read_b64 v[122:123], v13 offset:2184
    v_mfma_f32_16x16x32_bf16 v[228:231], v[24:27], v[60:63], v[228:231]
    ds_read_b64 v[124:125], v13 offset:2688
    v_mfma_f32_16x16x32_bf16 v[232:235], v[24:27], v[64:67], v[232:235]
    ds_read_b64 v[126:127], v13 offset:2696
    v_mfma_f32_16x16x32_bf16 v[236:239], v[24:27], v[68:71], v[236:239]
    ds_read_b64 v[128:129], v13 offset:3200
    v_mfma_f32_16x16x32_bf16 v[220:223], v[28:31], v[48:51], v[220:223]
    ds_read_b64 v[130:131], v13 offset:3208
    v_mfma_f32_16x16x32_bf16 v[224:227], v[28:31], v[52:55], v[224:227]
    ds_read_b64 v[132:133], v13 offset:3712
    v_mfma_f32_16x16x32_bf16 v[228:231], v[28:31], v[56:59], v[228:231]
    ds_read_b64 v[134:135], v13 offset:3720
    v_mfma_f32_16x16x32_bf16 v[232:235], v[28:31], v[60:63], v[232:235]
    v_mfma_f32_16x16x32_bf16 v[236:239], v[28:31], v[64:67], v[236:239]
    v_mfma_f32_16x16x32_bf16 v[224:227], v[32:35], v[48:51], v[224:227]
    v_mfma_f32_16x16x32_bf16 v[228:231], v[32:35], v[52:55], v[228:231]
    v_mfma_f32_16x16x32_bf16 v[232:235], v[32:35], v[56:59], v[232:235]
    v_mfma_f32_16x16x32_bf16 v[236:239], v[32:35], v[60:63], v[236:239]
    v_mfma_f32_16x16x32_bf16 v[228:231], v[36:39], v[48:51], v[228:231]
    v_mfma_f32_16x16x32_bf16 v[232:235], v[36:39], v[52:55], v[232:235]
    v_mfma_f32_16x16x32_bf16 v[236:239], v[36:39], v[56:59], v[236:239]
    v_mfma_f32_16x16x32_bf16 v[232:235], v[40:43], v[48:51], v[232:235]
    v_mfma_f32_16x16x32_bf16 v[236:239], v[40:43], v[52:55], v[236:239]
    v_mfma_f32_16x16x32_bf16 v[236:239], v[44:47], v[48:51], v[236:239]
    s_waitcnt lgkmcnt(0)
    buffer_load_dwordx2 v[88:89], v8, s[52:55], s62 offen
    v_mfma_f32_16x16x32_bf16 v[208:211], v[104:107], v[136:139], v[208:211]
    ds_read_b64 v[16:17], v13 offset:192
    v_mfma_f32_16x16x32_bf16 v[212:215], v[104:107], v[140:143], v[212:215]
    ds_read_b64 v[18:19], v13 offset:200
    v_mfma_f32_16x16x32_bf16 v[216:219], v[104:107], v[144:147], v[216:219]
    ds_read_b128 v[48:51], v14 offset:3776
    v_mfma_f32_16x16x32_bf16 v[220:223], v[104:107], v[148:151], v[220:223]
    ds_read_b128 v[52:55], v14 offset:3264
    v_mfma_f32_16x16x32_bf16 v[224:227], v[104:107], v[152:155], v[224:227]
    ds_read_b128 v[56:59], v14 offset:2752
    v_mfma_f32_16x16x32_bf16 v[228:231], v[104:107], v[156:159], v[228:231]
    ds_read_b128 v[60:63], v14 offset:2240
    v_mfma_f32_16x16x32_bf16 v[232:235], v[104:107], v[160:163], v[232:235]
    ds_read_b128 v[64:67], v14 offset:1728
    v_mfma_f32_16x16x32_bf16 v[236:239], v[104:107], v[164:167], v[236:239]
    ds_read_b128 v[68:71], v14 offset:1216
    v_mfma_f32_16x16x32_bf16 v[212:215], v[108:111], v[136:139], v[212:215]
    ds_read_b128 v[72:75], v14 offset:704
    v_mfma_f32_16x16x32_bf16 v[216:219], v[108:111], v[140:143], v[216:219]
    ds_read_b128 v[76:79], v14 offset:192
    v_mfma_f32_16x16x32_bf16 v[220:223], v[108:111], v[144:147], v[220:223]
    ds_read_b64 v[20:21], v13 offset:704
    v_mfma_f32_16x16x32_bf16 v[224:227], v[108:111], v[148:151], v[224:227]
    ds_read_b64 v[22:23], v13 offset:712
    v_mfma_f32_16x16x32_bf16 v[228:231], v[108:111], v[152:155], v[228:231]
    ds_read_b64 v[24:25], v13 offset:1216
    v_mfma_f32_16x16x32_bf16 v[232:235], v[108:111], v[156:159], v[232:235]
    ds_read_b64 v[26:27], v13 offset:1224
    v_mfma_f32_16x16x32_bf16 v[236:239], v[108:111], v[160:163], v[236:239]
    ds_read_b64 v[28:29], v13 offset:1728
    v_mfma_f32_16x16x32_bf16 v[216:219], v[112:115], v[136:139], v[216:219]
    ds_read_b64 v[30:31], v13 offset:1736
    v_mfma_f32_16x16x32_bf16 v[220:223], v[112:115], v[140:143], v[220:223]
    ds_read_b64 v[32:33], v13 offset:2240
    v_mfma_f32_16x16x32_bf16 v[224:227], v[112:115], v[144:147], v[224:227]
    ds_read_b64 v[34:35], v13 offset:2248
    v_mfma_f32_16x16x32_bf16 v[228:231], v[112:115], v[148:151], v[228:231]
    ds_read_b64 v[36:37], v13 offset:2752
    v_mfma_f32_16x16x32_bf16 v[232:235], v[112:115], v[152:155], v[232:235]
    ds_read_b64 v[38:39], v13 offset:2760
    v_mfma_f32_16x16x32_bf16 v[236:239], v[112:115], v[156:159], v[236:239]
    ds_read_b64 v[40:41], v13 offset:3264
    v_mfma_f32_16x16x32_bf16 v[220:223], v[116:119], v[136:139], v[220:223]
    ds_read_b64 v[42:43], v13 offset:3272
    v_mfma_f32_16x16x32_bf16 v[224:227], v[116:119], v[140:143], v[224:227]
    ds_read_b64 v[44:45], v13 offset:3776
    v_mfma_f32_16x16x32_bf16 v[228:231], v[116:119], v[144:147], v[228:231]
    ds_read_b64 v[46:47], v13 offset:3784
    v_mfma_f32_16x16x32_bf16 v[232:235], v[116:119], v[148:151], v[232:235]
    v_mfma_f32_16x16x32_bf16 v[236:239], v[116:119], v[152:155], v[236:239]
    v_mfma_f32_16x16x32_bf16 v[224:227], v[120:123], v[136:139], v[224:227]
    v_mfma_f32_16x16x32_bf16 v[228:231], v[120:123], v[140:143], v[228:231]
    v_mfma_f32_16x16x32_bf16 v[232:235], v[120:123], v[144:147], v[232:235]
    v_mfma_f32_16x16x32_bf16 v[236:239], v[120:123], v[148:151], v[236:239]
    v_mfma_f32_16x16x32_bf16 v[228:231], v[124:127], v[136:139], v[228:231]
    v_mfma_f32_16x16x32_bf16 v[232:235], v[124:127], v[140:143], v[232:235]
    v_mfma_f32_16x16x32_bf16 v[236:239], v[124:127], v[144:147], v[236:239]
    v_mfma_f32_16x16x32_bf16 v[232:235], v[128:131], v[136:139], v[232:235]
    v_mfma_f32_16x16x32_bf16 v[236:239], v[128:131], v[140:143], v[236:239]
    v_mfma_f32_16x16x32_bf16 v[236:239], v[132:135], v[136:139], v[236:239]
    s_waitcnt lgkmcnt(0)
    buffer_load_dwordx2 v[90:91], v8, s[52:55], s63 offen
    v_mfma_f32_16x16x32_bf16 v[208:211], v[16:19], v[48:51], v[208:211]
    ds_read_b64 v[92:93], v11 offset:3584
    v_mfma_f32_16x16x32_bf16 v[212:215], v[16:19], v[52:55], v[212:215]
    ds_read_b64 v[94:95], v11 offset:3072
    v_mfma_f32_16x16x32_bf16 v[216:219], v[16:19], v[56:59], v[216:219]
    ds_read_b64 v[96:97], v11 offset:2560
    v_mfma_f32_16x16x32_bf16 v[220:223], v[16:19], v[60:63], v[220:223]
    ds_read_b64 v[98:99], v11 offset:2048
    v_mfma_f32_16x16x32_bf16 v[224:227], v[16:19], v[64:67], v[224:227]
    v_mfma_f32_16x16x32_bf16 v[228:231], v[16:19], v[68:71], v[228:231]
    v_mfma_f32_16x16x32_bf16 v[232:235], v[16:19], v[72:75], v[232:235]
    v_mfma_f32_16x16x32_bf16 v[236:239], v[16:19], v[76:79], v[236:239]
    v_mfma_f32_16x16x32_bf16 v[212:215], v[20:23], v[48:51], v[212:215]
    v_mfma_f32_16x16x32_bf16 v[216:219], v[20:23], v[52:55], v[216:219]
    v_mfma_f32_16x16x32_bf16 v[220:223], v[20:23], v[56:59], v[220:223]
    v_mfma_f32_16x16x32_bf16 v[224:227], v[20:23], v[60:63], v[224:227]
    v_mfma_f32_16x16x32_bf16 v[228:231], v[20:23], v[64:67], v[228:231]
    v_mfma_f32_16x16x32_bf16 v[232:235], v[20:23], v[68:71], v[232:235]
    v_mfma_f32_16x16x32_bf16 v[236:239], v[20:23], v[72:75], v[236:239]
    v_mfma_f32_16x16x32_bf16 v[216:219], v[24:27], v[48:51], v[216:219]
    v_mfma_f32_16x16x32_bf16 v[220:223], v[24:27], v[52:55], v[220:223]
    v_mfma_f32_16x16x32_bf16 v[224:227], v[24:27], v[56:59], v[224:227]
    v_mfma_f32_16x16x32_bf16 v[228:231], v[24:27], v[60:63], v[228:231]
    v_mfma_f32_16x16x32_bf16 v[232:235], v[24:27], v[64:67], v[232:235]
    v_mfma_f32_16x16x32_bf16 v[236:239], v[24:27], v[68:71], v[236:239]
    v_mfma_f32_16x16x32_bf16 v[220:223], v[28:31], v[48:51], v[220:223]
    v_mfma_f32_16x16x32_bf16 v[224:227], v[28:31], v[52:55], v[224:227]
    v_mfma_f32_16x16x32_bf16 v[228:231], v[28:31], v[56:59], v[228:231]
    v_mfma_f32_16x16x32_bf16 v[232:235], v[28:31], v[60:63], v[232:235]
    v_mfma_f32_16x16x32_bf16 v[236:239], v[28:31], v[64:67], v[236:239]
    v_mfma_f32_16x16x32_bf16 v[224:227], v[32:35], v[48:51], v[224:227]
    v_mfma_f32_16x16x32_bf16 v[228:231], v[32:35], v[52:55], v[228:231]
    v_mfma_f32_16x16x32_bf16 v[232:235], v[32:35], v[56:59], v[232:235]
    v_mfma_f32_16x16x32_bf16 v[236:239], v[32:35], v[60:63], v[236:239]
    v_mfma_f32_16x16x32_bf16 v[228:231], v[36:39], v[48:51], v[228:231]
    v_mfma_f32_16x16x32_bf16 v[232:235], v[36:39], v[52:55], v[232:235]
    v_mfma_f32_16x16x32_bf16 v[236:239], v[36:39], v[56:59], v[236:239]
    v_mfma_f32_16x16x32_bf16 v[232:235], v[40:43], v[48:51], v[232:235]
    v_mfma_f32_16x16x32_bf16 v[236:239], v[40:43], v[52:55], v[236:239]
    v_mfma_f32_16x16x32_bf16 v[236:239], v[44:47], v[48:51], v[236:239]
    s_cmp_eq_u32 s33, 1
    s_cbranch_scc1 b2h1_34
    ds_write_b128 v7, v[224:227] offset:0
    ds_write_b128 v7, v[228:231] offset:1024
    s_nop 1
    ds_write_b128 v7, v[232:235] offset:2048
    s_nop 0
    ds_write_b128 v7, v[236:239] offset:3072
    v_mov_b64 v[192:193], v[208:209]
    v_mov_b64 v[194:195], v[210:211]
    v_mov_b64 v[196:197], v[212:213]
    v_mov_b64 v[198:199], v[214:215]
    v_mov_b64 v[200:201], v[216:217]
    v_mov_b64 v[202:203], v[218:219]
    v_mov_b64 v[204:205], v[220:221]
    v_mov_b64 v[206:207], v[222:223]
    s_branch b2x_35
b2h1_34:
    ds_write_b128 v7, v[208:211] offset:0
    ds_write_b128 v7, v[212:215] offset:1024
    ds_write_b128 v7, v[216:219] offset:2048
    ds_write_b128 v7, v[220:223] offset:3072
    v_mov_b64 v[192:193], v[224:225]
    v_mov_b64 v[194:195], v[226:227]
    v_mov_b64 v[196:197], v[228:229]
    v_mov_b64 v[198:199], v[230:231]
    v_mov_b64 v[200:201], v[232:233]
    v_mov_b64 v[202:203], v[234:235]
    v_mov_b64 v[204:205], v[236:237]
    v_mov_b64 v[206:207], v[238:239]
b2x_35:
    s_and_b32 s37, s37, 2
    s_lshl_b32 s37, s37, 3
    s_waitcnt lgkmcnt(0)
    s_lshr_b32 s39, s39, s37
    s_lshl_b32 s39, s39, 16
    v_and_b32 v16, 0xffff0000, v93
    v_lshlrev_b32 v17, 16, v93
    v_and_b32 v18, 0xffff0000, v92
    v_lshlrev_b32 v19, 16, v92
    v_and_b32 v20, 0xffff0000, v95
    v_lshlrev_b32 v21, 16, v95
    v_and_b32 v22, 0xffff0000, v94
    v_lshlrev_b32 v23, 16, v94
    v_and_b32 v24, 0xffff0000, v97
    v_lshlrev_b32 v25, 16, v97
    v_and_b32 v26, 0xffff0000, v96
    v_lshlrev_b32 v27, 16, v96
    v_and_b32 v28, 0xffff0000, v99
    v_lshlrev_b32 v29, 16, v99
    v_and_b32 v30, 0xffff0000, v98
    v_lshlrev_b32 v31, 16, v98
    v_fma_f32 v192, v16, s39, v192
    v_fma_f32 v193, v17, s39, v193
    v_fma_f32 v194, v18, s39, v194
    v_fma_f32 v195, v19, s39, v195
    v_fma_f32 v196, v20, s39, v196
    v_fma_f32 v197, v21, s39, v197
    v_fma_f32 v198, v22, s39, v198
    v_fma_f32 v199, v23, s39, v199
    v_fma_f32 v200, v24, s39, v200
    v_fma_f32 v201, v25, s39, v201
    v_fma_f32 v202, v26, s39, v202
    v_fma_f32 v203, v27, s39, v203
    v_fma_f32 v204, v28, s39, v204
    v_fma_f32 v205, v29, s39, v205
    v_fma_f32 v206, v30, s39, v206
    v_fma_f32 v207, v31, s39, v207
    s_barrier
    ds_read_b128 v[48:51], v6 offset:0
    ds_read_b128 v[52:55], v6 offset:1024
    ds_read_b128 v[56:59], v6 offset:2048
    ds_read_b128 v[60:63], v6 offset:3072
    s_waitcnt lgkmcnt(3)
    v_add_f32 v192, v192, v48
    v_add_f32 v193, v193, v49
    v_add_f32 v194, v194, v50
    v_add_f32 v195, v195, v51
    v_cvt_pk_bf16_f32 v64, v192, v193
    v_cvt_pk_bf16_f32 v65, v194, v195
    ds_write_b64 v9, v[64:65] offset:0
    s_waitcnt lgkmcnt(2)
    v_add_f32 v196, v196, v52
    v_add_f32 v197, v197, v53
    v_add_f32 v198, v198, v54
    v_add_f32 v199, v199, v55
    v_cvt_pk_bf16_f32 v66, v196, v197
    v_cvt_pk_bf16_f32 v67, v198, v199
    ds_write_b64 v9, v[66:67] offset:512
    s_waitcnt lgkmcnt(1)
    v_add_f32 v200, v200, v56
    v_add_f32 v201, v201, v57
    v_add_f32 v202, v202, v58
    v_add_f32 v203, v203, v59
    v_cvt_pk_bf16_f32 v68, v200, v201
    v_cvt_pk_bf16_f32 v69, v202, v203
    ds_write_b64 v9, v[68:69] offset:1024
    s_waitcnt lgkmcnt(0)
    v_add_f32 v204, v204, v60
    v_add_f32 v205, v205, v61
    v_add_f32 v206, v206, v62
    v_add_f32 v207, v207, v63
    v_cvt_pk_bf16_f32 v70, v204, v205
    v_cvt_pk_bf16_f32 v71, v206, v207
    ds_write_b64 v9, v[70:71] offset:1536
    s_waitcnt vmcnt(0)
    v_lshlrev_b32 v32, 16, v84
    v_and_b32 v33, 0xffff0000, v84
    v_lshlrev_b32 v34, 16, v85
    v_and_b32 v35, 0xffff0000, v85
    v_lshlrev_b32 v36, 16, v86
    v_and_b32 v37, 0xffff0000, v86
    v_lshlrev_b32 v38, 16, v87
    v_and_b32 v39, 0xffff0000, v87
    v_lshlrev_b32 v40, 16, v88
    v_and_b32 v41, 0xffff0000, v88
    v_lshlrev_b32 v42, 16, v89
    v_and_b32 v43, 0xffff0000, v89
    v_lshlrev_b32 v44, 16, v90
    v_and_b32 v45, 0xffff0000, v90
    v_lshlrev_b32 v46, 16, v91
    v_and_b32 v47, 0xffff0000, v91
    v_lshrrev_b32 v12, 2, v3
    v_mul_u32_u24 v12, 4160, v12
    v_and_b32 v13, 3, v3
    v_lshl_add_u32 v12, v13, 3, v12
    v_lshl_add_u32 v12, v4, 5, v12
    s_lshl_b32 s41, s29, 9
    v_add_u32 v12, s41, v12
    s_lshl_b32 s41, s29, 8
    v_add_u32 v13, s41, v1
    s_movk_i32 s42, 2304
    s_lshl_b32 s43, s90, 3
    s_add_u32 s43, s43, 1152
    v_mul_lo_u32 v13, v13, s42
    v_add_u32 v13, s43, v13
    s_mov_b32 s60, 0
    s_mov_b32 s61, 147456
    s_mov_b32 s62, 294912
    s_mov_b32 s63, 442368
    s_waitcnt lgkmcnt(0)
    s_barrier
    ds_read_b64_tr_b16 v[16:17], v12 offset:0
    ds_read_b64_tr_b16 v[18:19], v12 offset:128
    ds_read_b64_tr_b16 v[20:21], v12 offset:256
    ds_read_b64_tr_b16 v[22:23], v12 offset:384
    s_waitcnt lgkmcnt(3)
    v_lshlrev_b32 v48, 16, v16
    v_and_b32 v49, 0xffff0000, v16
    v_lshlrev_b32 v50, 16, v17
    v_and_b32 v51, 0xffff0000, v17
    v_mul_f32 v48, v48, v32
    v_mul_f32 v49, v49, v33
    v_mul_f32 v50, v50, v34
    v_mul_f32 v51, v51, v35
    v_cvt_pk_bf16_f32 v64, v48, v49
    v_cvt_pk_bf16_f32 v65, v50, v51
    buffer_store_dwordx2 v[64:65], v13, s[56:59], s60 offen
    s_waitcnt lgkmcnt(2)
    v_lshlrev_b32 v52, 16, v18
    v_and_b32 v53, 0xffff0000, v18
    v_lshlrev_b32 v54, 16, v19
    v_and_b32 v55, 0xffff0000, v19
    v_mul_f32 v52, v52, v36
    v_mul_f32 v53, v53, v37
    v_mul_f32 v54, v54, v38
    v_mul_f32 v55, v55, v39
    v_cvt_pk_bf16_f32 v66, v52, v53
    v_cvt_pk_bf16_f32 v67, v54, v55
    buffer_store_dwordx2 v[66:67], v13, s[56:59], s61 offen
    s_waitcnt lgkmcnt(1)
    v_lshlrev_b32 v56, 16, v20
    v_and_b32 v57, 0xffff0000, v20
    v_lshlrev_b32 v58, 16, v21
    v_and_b32 v59, 0xffff0000, v21
    v_mul_f32 v56, v56, v40
    v_mul_f32 v57, v57, v41
    v_mul_f32 v58, v58, v42
    v_mul_f32 v59, v59, v43
    v_cvt_pk_bf16_f32 v68, v56, v57
    v_cvt_pk_bf16_f32 v69, v58, v59
    buffer_store_dwordx2 v[68:69], v13, s[56:59], s62 offen
    s_waitcnt lgkmcnt(0)
    v_lshlrev_b32 v60, 16, v22
    v_and_b32 v61, 0xffff0000, v22
    v_lshlrev_b32 v62, 16, v23
    v_and_b32 v63, 0xffff0000, v23
    v_mul_f32 v60, v60, v44
    v_mul_f32 v61, v61, v45
    v_mul_f32 v62, v62, v46
    v_mul_f32 v63, v63, v47
    v_cvt_pk_bf16_f32 v70, v60, v61
    v_cvt_pk_bf16_f32 v71, v62, v63
    buffer_store_dwordx2 v[70:71], v13, s[56:59], s63 offen
L_fin:
L_end:
    s_endpgm
.section .rodata,"a"
.p2align 6
.amdhsa_kernel concat_heads__sliding_local_dilated__ssm_conv_h3__prompt_kernel
  .amdhsa_next_free_vgpr 256
  .amdhsa_next_free_sgpr 102
  .amdhsa_accum_offset 256
  .amdhsa_group_segment_fixed_size 0
  .amdhsa_kernarg_size 96
  .amdhsa_user_sgpr_count 2
  .amdhsa_user_sgpr_kernarg_segment_ptr 1
  .amdhsa_system_sgpr_workgroup_id_x 1
.end_amdhsa_kernel
```
